```python
import torch

def _softmax(x, axis=-1):
    return torch.softmax(x, dim=axis)
def _gelu(x):
    return torch.nn.functional.gelu(x, approximate="tanh")
def _silu(x):
    return torch.nn.functional.silu(x)
def _sigmoid(x):
    return torch.sigmoid(x)
def _layernorm(x, axis=-1, eps=1e-5):
    m = x.mean(dim=axis, keepdim=True)
    v = x.var(dim=axis, keepdim=True, unbiased=False)
    return (x - m) / torch.sqrt(v + eps)
def _scatter_add(tgt, idx, src, axis=0):
    return tgt.clone().index_add_(axis, idx, src)
def _segment_sum(src, seg, n):
    out = torch.zeros((n,) + src.shape[1:], dtype=src.dtype)
    return out.index_add_(0, seg, src)
def _pad(x, pw):
    flat = tuple(v for pair in reversed(pw) for v in pair)
    return torch.nn.functional.pad(x, flat)

kernel_name = 'concat_heads__gqa_block_cached__mha_block_cached__near_ridge'

def setup_inputs():

    _w = (lambda a: (lambda t: t.to(torch.bfloat16) if t.is_floating_point() else t)(torch.as_tensor(a)))
    def _A_setup():
        B, Sq, D = 8, 96, 640
        Hq, Hkv, Sk, Dh = 32, 32, 96, 128
        assert Hq % Hkv == 0, (Hq, Hkv)
        return {
            "x": _w((lambda *s: torch.randn(*s, dtype=torch.bfloat16) * 0.8)(B, Sq, D)),
            "k_cache": _w((lambda *s: torch.randn(*s, dtype=torch.bfloat16) * 0.8)(B, Hkv, Sk, Dh)),
            "v_cache": _w((lambda *s: torch.randn(*s, dtype=torch.bfloat16) * 0.05)(B, Hkv, Sk, Dh)),
            "wq": _w((lambda *s: torch.randn(*s, dtype=torch.bfloat16) * 0.8)(D, Hq * Dh) * (D ** -0.5)),
            "wo": _w((lambda *s: torch.randn(*s, dtype=torch.bfloat16) * 0.05)(Hq * Dh, D) * ((Hq * Dh) ** -0.5)),
        }
    _A_in = _A_setup()

    def _B_setup():
        B, Sq, D = 8, 96, 640
        H, Sk, Dh = 32, 96, 128
        return {
            "x": _w((lambda *s: torch.randn(*s, dtype=torch.bfloat16) * 0.8)(B, Sq, D)),
            "k_cache": _w((lambda *s: torch.randn(*s, dtype=torch.bfloat16) * 0.8)(B, H, Sk, Dh)),
            "v_cache": _w((lambda *s: torch.randn(*s, dtype=torch.bfloat16) * 0.05)(B, H, Sk, Dh)),
            "wq": _w((lambda *s: torch.randn(*s, dtype=torch.bfloat16) * 0.8)(D, H * Dh) * (D ** -0.5)),
            "wo": _w((lambda *s: torch.randn(*s, dtype=torch.bfloat16) * 0.05)(H * Dh, D) * ((H * Dh) ** -0.5)),
        }
    _B_in = _B_setup()

    return {
        "A_x": _A_in["x"],
        "A_k_cache": _A_in["k_cache"],
        "A_v_cache": _A_in["v_cache"],
        "A_wq": _A_in["wq"],
        "A_wo": _A_in["wo"],
        "B_x": _B_in["x"],
        "B_k_cache": _B_in["k_cache"],
        "B_v_cache": _B_in["v_cache"],
        "B_wq": _B_in["wq"],
        "B_wo": _B_in["wo"],
    }

def reference(A_x, A_k_cache, A_v_cache, A_wq, A_wo, B_x, B_k_cache, B_v_cache, B_wq, B_wo):
    def _A_ref(x, k_cache, v_cache, wq, wo):
        B, Sq, D = x.shape
        Hq, Dh = 32, 128
        Hkv = k_cache.shape[1]
        rep = Hq // Hkv
        q = (lambda x, *d: x.permute(*d))((x @ wq).reshape(B, Sq, Hq, Dh), 0, 2, 1, 3)
        k = (lambda x, n, axis: torch.repeat_interleave(x, n, dim=axis))(k_cache, rep, axis=1)
        v = (lambda x, n, axis: torch.repeat_interleave(x, n, dim=axis))(v_cache, rep, axis=1)
        scores = torch.einsum("bhqd,bhkd->bhqk", q, k) * (Dh ** -0.5)
        p = _softmax(scores, axis=-1)
        o = torch.einsum("bhqk,bhkd->bhqd", p, v)
        return (lambda x, *d: x.permute(*d))(o, 0, 2, 1, 3).reshape(B, Sq, Hq * Dh) @ wo

    def _B_ref(x, k_cache, v_cache, wq, wo):
        B, Sq, D = x.shape
        H, Dh = 32, 128
        q = (lambda x, *d: x.permute(*d))((x @ wq).reshape(B, Sq, H, Dh), 0, 2, 1, 3)
        scores = torch.einsum("bhqd,bhkd->bhqk", q, k_cache) * (Dh ** -0.5)
        p = _softmax(scores, axis=-1)
        o = torch.einsum("bhqk,bhkd->bhqd", p, v_cache)
        return (lambda x, *d: x.permute(*d))(o, 0, 2, 1, 3).reshape(B, Sq, H * Dh) @ wo

    a = _A_ref(A_x, A_k_cache, A_v_cache, A_wq, A_wo)
    b = _B_ref(B_x, B_k_cache, B_v_cache, B_wq, B_wo)
    return torch.concatenate([a, b], axis=-1)
```

```asm
; @launch grid=(256,1,1) block=(512,1,1) lds=163840
.amdgcn_target "amdgcn-amd-amdhsa--gfx950"
.text
.globl concat_heads__gqa_block_cached__mha_block_cached__near_ridge_kernel
.p2align 8
.type concat_heads__gqa_block_cached__mha_block_cached__near_ridge_kernel,@function
concat_heads__gqa_block_cached__mha_block_cached__near_ridge_kernel:
    s_cmp_ge_u32 s2, 256
    s_cbranch_scc1 L_END
    s_and_b32 s3, s2, 7
    s_lshr_b32 s4, s3, 2
    s_mul_i32 s5, s4, 40
    s_load_dwordx8 s[8:15], s[0:1], s5
    s_load_dwordx2 s[16:17], s[0:1], s5 offset:32
    s_load_dwordx4 s[20:23], s[0:1], 80
    s_load_dwordx2 s[24:25], s[0:1], 96
    v_cmp_gt_u32 vcc, 8, v0
    s_and_saveexec_b64 s[18:19], vcc
    s_cbranch_execz L_NOCPF
    s_getpc_b64 s[90:91]
L_PC:
    s_and_b32 s18, s2, 0xf8
    v_add_u32 v2, s18, v0
    v_lshlrev_b32 v2, 7, v2
    v_min_u32 v2, L_END-L_PC, v2
    v_add_co_u32 v2, vcc, s90, v2
    v_mov_b32 v3, s91
    s_nop 0
    v_addc_co_u32 v3, vcc, 0, v3, vcc
    global_load_dword v235, v[2:3], off
L_NOCPF:
    s_mov_b64 exec, -1
    v_lshrrev_b32 v1, 6, v0
    v_xor_b32 v1, 4, v1
    s_lshr_b32 s6, s2, 3
    v_readfirstlane_b32 s7, v1
    v_and_b32 v0, 63, v0
    s_bfe_u32 s26, s6, 0x10002
    s_lshr_b32 s27, s6, 3
    s_and_b32 s6, s6, 3
    s_lshl_b32 s27, s27, 2
    s_lshl_b32 s26, s26, 4
    s_or_b32 s6, s6, s27
    s_or_b32 s6, s6, s26
    s_and_b32 s97, s3, 3
    s_and_b32 s27, s6, 7
    s_lshl3_add_u32 s26, s97, s27
    s_lshr_b32 s28, s6, 3
    s_cmp_lt_u32 s7, 4
    s_cbranch_scc1 L_COMPUTE
    s_sub_u32 s19, s7, 4
    s_add_u32 s30, s27, s28
    s_and_b32 s30, s30, 3
    s_lshl_b32 s30, s30, 2
    s_lshr_b32 s30, 0x6420, s30
    s_and_b32 s30, s30, 15
    v_lshrrev_b32 v1, 4, v0
    v_and_b32 v2, 15, v0
    v_lshlrev_b32 v3, 1, v1
    v_xor_b32 v4, v2, v3
    v_lshlrev_b32 v4, 4, v4
    s_lshl_b32 s29, s19, 4
    v_add_u32 v5, s29, v1
    v_lshl_add_u32 v14, v5, 13, v4
    v_add_u32 v15, 31744, v14
    v_xor_b32 v5, 128, v14
    v_add_u32 v16, 63488, v5
    v_add_u32 v17, 95232, v5
    v_lshrrev_b32 v5, 3, v0
    v_and_b32 v6, 7, v0
    v_and_b32 v7, 6, v5
    v_xor_b32 v6, v6, v7
    s_mul_i32 s29, s19, 48
    v_add_u32 v5, s29, v5
    v_mul_u32_u24 v5, 1280, v5
    v_lshl_add_u32 v10, v6, 4, v5
    v_add_u32 v11, 9216, v10
    v_add_u32 v12, 18432, v10
    v_add_u32 v13, 27648, v10
    s_mul_i32 s88, s19, 6144
    s_lshl_b32 s89, s19, 12
    s_mul_i32 s29, s28, 245760
    s_lshl_b32 s31, s26, 8
    s_sub_u32 s38, 5242880, s31
    s_mov_b32 s39, 0x20000
    s_mov_b32 s34, 245760
    s_mov_b32 s35, 0x20000
    s_mov_b32 s100, 0
    s_waitcnt lgkmcnt(0)
    s_add_u32 s36, s14, s31
    s_addc_u32 s37, s15, 0
    s_add_u32 s32, s8, s29
    s_addc_u32 s33, s9, 0
    s_bitcmp1_b32 0xffff, s6
    s_cbranch_scc0 L_H1
    s_add_u32 m0, s89, 24576
    s_mov_b32 s90, 4718592
    buffer_load_dwordx4 v14, s[36:39], s90 offen offset:0 lds
    buffer_load_dwordx4 v15, s[36:39], s90 offen offset:1024 lds
    buffer_load_dwordx4 v16, s[36:39], s90 offen offset:2048 lds
    buffer_load_dwordx4 v17, s[36:39], s90 offen offset:3072 lds
    s_add_u32 m0, s88, 0
    s_mov_b32 s91, 1152
    buffer_load_dwordx4 v10, s[32:35], s91 offen offset:0 lds
    buffer_load_dwordx4 v11, s[32:35], s91 offen offset:1024 lds
    buffer_load_dwordx4 v12, s[32:35], s91 offen offset:2048 lds
    buffer_load_dwordx4 v13, s[32:35], s91 offen offset:3072 lds
    s_add_u32 m0, m0, 4096
    s_add_u32 s91, s91, 40960
    buffer_load_dwordx4 v10, s[32:35], s91 offen offset:0 lds
    buffer_load_dwordx4 v11, s[32:35], s91 offen offset:1024 lds
    s_add_u32 m0, s89, 106496
    s_lshl_b32 s90, s30, 19
    buffer_load_dwordx4 v14, s[36:39], s90 offen offset:0 lds
    buffer_load_dwordx4 v15, s[36:39], s90 offen offset:1024 lds
    buffer_load_dwordx4 v16, s[36:39], s90 offen offset:2048 lds
    buffer_load_dwordx4 v17, s[36:39], s90 offen offset:3072 lds
    s_add_u32 m0, s88, 81920
    s_lshl_b32 s91, s30, 7
    buffer_load_dwordx4 v10, s[32:35], s91 offen offset:0 lds
    buffer_load_dwordx4 v11, s[32:35], s91 offen offset:1024 lds
    buffer_load_dwordx4 v12, s[32:35], s91 offen offset:2048 lds
    buffer_load_dwordx4 v13, s[32:35], s91 offen offset:3072 lds
    s_add_u32 m0, m0, 4096
    s_add_u32 s91, s91, 40960
    buffer_load_dwordx4 v10, s[32:35], s91 offen offset:0 lds
    buffer_load_dwordx4 v11, s[32:35], s91 offen offset:1024 lds
    s_add_u32 s30, s30, 1
    s_cmp_eq_u32 s30, 9
    s_cselect_b32 s30, 0, s30
    s_lshl_b32 s29, s28, 6
    s_add_u32 s29, s29, s26
    s_mul_i32 s29, s29, 24576
    s_add_u32 s44, s12, s29
    s_addc_u32 s45, s13, 0
    s_mov_b32 s46, 811008
    s_mov_b32 s47, 0x20000
    s_add_u32 s40, s10, s29
    s_addc_u32 s41, s11, 0
    s_mov_b32 s42, 811008
    s_mov_b32 s43, 0x20000
    v_lshlrev_b32 v18, 4, v0
    s_and_b32 s31, s19, 1
    s_lshl_b32 s31, s31, 7
    v_xor_b32 v19, s31, v4
    v_lshl_add_u32 v19, v1, 8, v19
    s_lshl_b32 s93, s19, 10
    v_add_u32 v19, s93, v19
    s_lshl_b32 s31, s19, 2
    v_add_u32 v5, s31, v1
    v_xor_b32 v6, v2, v5
    v_lshlrev_b32 v6, 4, v6
    v_lshl_add_u32 v20, v5, 8, v6
    s_waitcnt vmcnt(10)
    s_barrier
    s_add_u32 m0, s89, 65536
    s_lshl_b32 s90, s30, 19
    buffer_load_dwordx4 v14, s[36:39], s90 offen offset:0 lds
    buffer_load_dwordx4 v15, s[36:39], s90 offen offset:1024 lds
    buffer_load_dwordx4 v16, s[36:39], s90 offen offset:2048 lds
    buffer_load_dwordx4 v17, s[36:39], s90 offen offset:3072 lds
    s_add_u32 m0, s88, 40960
    s_lshl_b32 s91, s30, 7
    buffer_load_dwordx4 v10, s[32:35], s91 offen offset:0 lds
    buffer_load_dwordx4 v11, s[32:35], s91 offen offset:1024 lds
    buffer_load_dwordx4 v12, s[32:35], s91 offen offset:2048 lds
    buffer_load_dwordx4 v13, s[32:35], s91 offen offset:3072 lds
    s_add_u32 m0, m0, 4096
    s_add_u32 s91, s91, 40960
    buffer_load_dwordx4 v10, s[32:35], s91 offen offset:0 lds
    buffer_load_dwordx4 v11, s[32:35], s91 offen offset:1024 lds
    s_add_u32 s30, s30, 1
    s_cmp_eq_u32 s30, 9
    s_cselect_b32 s30, 0, s30
    s_waitcnt vmcnt(10)
    s_barrier
    s_add_u32 m0, s89, 24576
    s_lshl_b32 s90, s30, 19
    buffer_load_dwordx4 v14, s[36:39], s90 offen offset:0 lds
    buffer_load_dwordx4 v15, s[36:39], s90 offen offset:1024 lds
    buffer_load_dwordx4 v16, s[36:39], s90 offen offset:2048 lds
    buffer_load_dwordx4 v17, s[36:39], s90 offen offset:3072 lds
    s_add_u32 m0, s88, 0
    s_lshl_b32 s91, s30, 7
    buffer_load_dwordx4 v10, s[32:35], s91 offen offset:0 lds
    buffer_load_dwordx4 v11, s[32:35], s91 offen offset:1024 lds
    buffer_load_dwordx4 v12, s[32:35], s91 offen offset:2048 lds
    buffer_load_dwordx4 v13, s[32:35], s91 offen offset:3072 lds
    s_add_u32 m0, m0, 4096
    s_add_u32 s91, s91, 40960
    buffer_load_dwordx4 v10, s[32:35], s91 offen offset:0 lds
    buffer_load_dwordx4 v11, s[32:35], s91 offen offset:1024 lds
    s_add_u32 s30, s30, 1
    s_cmp_eq_u32 s30, 9
    s_cselect_b32 s30, 0, s30
    s_waitcnt vmcnt(10)
    s_barrier
    s_add_u32 m0, s89, 106496
    s_lshl_b32 s90, s30, 19
    buffer_load_dwordx4 v14, s[36:39], s90 offen offset:0 lds
    buffer_load_dwordx4 v15, s[36:39], s90 offen offset:1024 lds
    buffer_load_dwordx4 v16, s[36:39], s90 offen offset:2048 lds
    buffer_load_dwordx4 v17, s[36:39], s90 offen offset:3072 lds
    s_add_u32 m0, s88, 81920
    s_lshl_b32 s91, s30, 7
    buffer_load_dwordx4 v10, s[32:35], s91 offen offset:0 lds
    buffer_load_dwordx4 v11, s[32:35], s91 offen offset:1024 lds
    buffer_load_dwordx4 v12, s[32:35], s91 offen offset:2048 lds
    buffer_load_dwordx4 v13, s[32:35], s91 offen offset:3072 lds
    s_add_u32 m0, m0, 4096
    s_add_u32 s91, s91, 40960
    buffer_load_dwordx4 v10, s[32:35], s91 offen offset:0 lds
    buffer_load_dwordx4 v11, s[32:35], s91 offen offset:1024 lds
    s_add_u32 s30, s30, 1
    s_cmp_eq_u32 s30, 9
    s_cselect_b32 s30, 0, s30
    s_waitcnt vmcnt(10)
    s_barrier
    s_add_u32 m0, s89, 65536
    s_lshl_b32 s90, s30, 19
    buffer_load_dwordx4 v14, s[36:39], s90 offen offset:0 lds
    buffer_load_dwordx4 v15, s[36:39], s90 offen offset:1024 lds
    buffer_load_dwordx4 v16, s[36:39], s90 offen offset:2048 lds
    buffer_load_dwordx4 v17, s[36:39], s90 offen offset:3072 lds
    s_add_u32 m0, s88, 40960
    s_lshl_b32 s91, s30, 7
    buffer_load_dwordx4 v10, s[32:35], s91 offen offset:0 lds
    buffer_load_dwordx4 v11, s[32:35], s91 offen offset:1024 lds
    buffer_load_dwordx4 v12, s[32:35], s91 offen offset:2048 lds
    buffer_load_dwordx4 v13, s[32:35], s91 offen offset:3072 lds
    s_add_u32 m0, m0, 4096
    s_add_u32 s91, s91, 40960
    buffer_load_dwordx4 v10, s[32:35], s91 offen offset:0 lds
    buffer_load_dwordx4 v11, s[32:35], s91 offen offset:1024 lds
    s_add_u32 s30, s30, 1
    s_cmp_eq_u32 s30, 9
    s_cselect_b32 s30, 0, s30
    s_waitcnt vmcnt(10)
    s_barrier
    s_add_u32 m0, s89, 24576
    s_lshl_b32 s90, s30, 19
    buffer_load_dwordx4 v14, s[36:39], s90 offen offset:0 lds
    buffer_load_dwordx4 v15, s[36:39], s90 offen offset:1024 lds
    buffer_load_dwordx4 v16, s[36:39], s90 offen offset:2048 lds
    buffer_load_dwordx4 v17, s[36:39], s90 offen offset:3072 lds
    s_add_u32 m0, s88, 0
    s_lshl_b32 s91, s30, 7
    buffer_load_dwordx4 v10, s[32:35], s91 offen offset:0 lds
    buffer_load_dwordx4 v11, s[32:35], s91 offen offset:1024 lds
    buffer_load_dwordx4 v12, s[32:35], s91 offen offset:2048 lds
    buffer_load_dwordx4 v13, s[32:35], s91 offen offset:3072 lds
    s_add_u32 m0, m0, 4096
    s_add_u32 s91, s91, 40960
    buffer_load_dwordx4 v10, s[32:35], s91 offen offset:0 lds
    buffer_load_dwordx4 v11, s[32:35], s91 offen offset:1024 lds
    s_add_u32 s30, s30, 1
    s_cmp_eq_u32 s30, 9
    s_cselect_b32 s30, 0, s30
    s_waitcnt vmcnt(10)
    s_barrier
    s_add_u32 m0, s89, 106496
    s_lshl_b32 s90, s30, 19
    buffer_load_dwordx4 v14, s[36:39], s90 offen offset:0 lds
    buffer_load_dwordx4 v15, s[36:39], s90 offen offset:1024 lds
    buffer_load_dwordx4 v16, s[36:39], s90 offen offset:2048 lds
    buffer_load_dwordx4 v17, s[36:39], s90 offen offset:3072 lds
    s_add_u32 m0, s88, 81920
    s_lshl_b32 s91, s30, 7
    buffer_load_dwordx4 v10, s[32:35], s91 offen offset:0 lds
    buffer_load_dwordx4 v11, s[32:35], s91 offen offset:1024 lds
    buffer_load_dwordx4 v12, s[32:35], s91 offen offset:2048 lds
    buffer_load_dwordx4 v13, s[32:35], s91 offen offset:3072 lds
    s_add_u32 m0, m0, 4096
    s_add_u32 s91, s91, 40960
    buffer_load_dwordx4 v10, s[32:35], s91 offen offset:0 lds
    buffer_load_dwordx4 v11, s[32:35], s91 offen offset:1024 lds
    s_add_u32 s30, s30, 1
    s_cmp_eq_u32 s30, 9
    s_cselect_b32 s30, 0, s30
    s_waitcnt vmcnt(10)
    s_barrier
    s_add_u32 m0, s89, 65536
    s_lshl_b32 s90, s30, 19
    buffer_load_dwordx4 v14, s[36:39], s90 offen offset:0 lds
    buffer_load_dwordx4 v15, s[36:39], s90 offen offset:1024 lds
    buffer_load_dwordx4 v16, s[36:39], s90 offen offset:2048 lds
    buffer_load_dwordx4 v17, s[36:39], s90 offen offset:3072 lds
    s_add_u32 m0, s88, 40960
    s_lshl_b32 s91, s30, 7
    buffer_load_dwordx4 v10, s[32:35], s91 offen offset:0 lds
    buffer_load_dwordx4 v11, s[32:35], s91 offen offset:1024 lds
    buffer_load_dwordx4 v12, s[32:35], s91 offen offset:2048 lds
    buffer_load_dwordx4 v13, s[32:35], s91 offen offset:3072 lds
    s_add_u32 m0, m0, 4096
    s_add_u32 s91, s91, 40960
    buffer_load_dwordx4 v10, s[32:35], s91 offen offset:0 lds
    buffer_load_dwordx4 v11, s[32:35], s91 offen offset:1024 lds
    s_add_u32 s30, s30, 1
    s_cmp_eq_u32 s30, 9
    s_cselect_b32 s30, 0, s30
    s_waitcnt vmcnt(10)
    s_barrier
    s_add_u32 m0, s89, 24576
    s_lshl_b32 s90, s30, 19
    buffer_load_dwordx4 v14, s[36:39], s90 offen offset:0 lds
    buffer_load_dwordx4 v15, s[36:39], s90 offen offset:1024 lds
    buffer_load_dwordx4 v16, s[36:39], s90 offen offset:2048 lds
    buffer_load_dwordx4 v17, s[36:39], s90 offen offset:3072 lds
    s_add_u32 m0, s88, 0
    s_lshl_b32 s91, s30, 7
    buffer_load_dwordx4 v10, s[32:35], s91 offen offset:0 lds
    buffer_load_dwordx4 v11, s[32:35], s91 offen offset:1024 lds
    buffer_load_dwordx4 v12, s[32:35], s91 offen offset:2048 lds
    buffer_load_dwordx4 v13, s[32:35], s91 offen offset:3072 lds
    s_add_u32 m0, m0, 4096
    s_add_u32 s91, s91, 40960
    buffer_load_dwordx4 v10, s[32:35], s91 offen offset:0 lds
    buffer_load_dwordx4 v11, s[32:35], s91 offen offset:1024 lds
    s_add_u32 m0, s93, 122880
    s_mov_b32 s90, 0
    buffer_load_dwordx4 v20, s[40:43], s90 offen nt lds
    s_add_u32 m0, s93, 126976
    s_mov_b32 s90, 786432
    buffer_load_dwordx4 v20, s[40:43], s90 offen nt lds
    s_add_u32 m0, s93, 131072
    s_mov_b32 s90, 4096
    buffer_load_dwordx4 v20, s[40:43], s90 offen nt lds
    s_add_u32 m0, s93, 135168
    s_mov_b32 s90, 790528
    buffer_load_dwordx4 v20, s[40:43], s90 offen nt lds
    s_add_u32 m0, s93, 139264
    s_mov_b32 s90, 8192
    buffer_load_dwordx4 v20, s[40:43], s90 offen nt lds
    s_add_u32 m0, s93, 143360
    s_mov_b32 s90, 794624
    buffer_load_dwordx4 v20, s[40:43], s90 offen nt lds
    s_waitcnt vmcnt(16)
    s_barrier
    s_add_u32 m0, s93, 147456
    s_mov_b32 s90, 12288
    buffer_load_dwordx4 v20, s[40:43], s90 offen nt lds
    s_add_u32 m0, s93, 151552
    s_mov_b32 s90, 798720
    buffer_load_dwordx4 v20, s[40:43], s90 offen nt lds
    s_add_u32 m0, s93, 155648
    s_mov_b32 s90, 16384
    buffer_load_dwordx4 v20, s[40:43], s90 offen nt lds
    s_add_u32 m0, s93, 159744
    s_mov_b32 s90, 802816
    buffer_load_dwordx4 v20, s[40:43], s90 offen nt lds
    s_add_u32 m0, s93, 114688
    s_mov_b32 s90, 20480
    buffer_load_dwordx4 v20, s[40:43], s90 offen nt lds
    s_add_u32 m0, s93, 118784
    s_mov_b32 s90, 806912
    buffer_load_dwordx4 v20, s[40:43], s90 offen nt lds
    s_waitcnt vmcnt(12)
    s_barrier
    s_add_u32 m0, s93, 90112
    s_mov_b32 s90, 0
    buffer_load_dwordx4 v19, s[44:47], s90 offen nt lds
    s_add_u32 m0, s93, 94208
    s_mov_b32 s90, 4096
    buffer_load_dwordx4 v19, s[44:47], s90 offen nt lds
    s_add_u32 m0, s93, 98304
    s_mov_b32 s90, 8192
    buffer_load_dwordx4 v19, s[44:47], s90 offen nt lds
    s_add_u32 m0, s93, 102400
    s_mov_b32 s90, 12288
    buffer_load_dwordx4 v19, s[44:47], s90 offen nt lds
    s_add_u32 m0, s93, 106496
    s_mov_b32 s90, 16384
    buffer_load_dwordx4 v19, s[44:47], s90 offen nt lds
    s_add_u32 m0, s93, 110592
    s_mov_b32 s90, 20480
    buffer_load_dwordx4 v19, s[44:47], s90 offen nt lds
    s_waitcnt vmcnt(6)
    s_barrier
    s_add_u32 m0, s93, 49152
    s_mov_b32 s90, 786432
    buffer_load_dwordx4 v19, s[44:47], s90 offen nt lds
    s_add_u32 m0, s93, 53248
    s_mov_b32 s90, 790528
    buffer_load_dwordx4 v19, s[44:47], s90 offen nt lds
    s_add_u32 m0, s93, 57344
    s_mov_b32 s90, 794624
    buffer_load_dwordx4 v19, s[44:47], s90 offen nt lds
    s_add_u32 m0, s93, 61440
    s_mov_b32 s90, 798720
    buffer_load_dwordx4 v19, s[44:47], s90 offen nt lds
    s_add_u32 m0, s93, 65536
    s_mov_b32 s90, 802816
    buffer_load_dwordx4 v19, s[44:47], s90 offen nt lds
    s_add_u32 m0, s93, 69632
    s_mov_b32 s90, 806912
    buffer_load_dwordx4 v19, s[44:47], s90 offen nt lds
    s_branch L_HX
L_H1:
    s_add_u32 m0, s89, 24576
    s_mov_b32 s90, 4718592
    buffer_load_dwordx4 v14, s[36:39], s90 offen offset:0 lds
    buffer_load_dwordx4 v15, s[36:39], s90 offen offset:1024 lds
    buffer_load_dwordx4 v16, s[36:39], s90 offen offset:2048 lds
    buffer_load_dwordx4 v17, s[36:39], s90 offen offset:3072 lds
    s_add_u32 m0, s88, 0
    s_mov_b32 s91, 1152
    buffer_load_dwordx4 v10, s[32:35], s91 offen offset:0 lds
    buffer_load_dwordx4 v11, s[32:35], s91 offen offset:1024 lds
    buffer_load_dwordx4 v12, s[32:35], s91 offen offset:2048 lds
    buffer_load_dwordx4 v13, s[32:35], s91 offen offset:3072 lds
    s_add_u32 m0, m0, 4096
    s_add_u32 s91, s91, 40960
    buffer_load_dwordx4 v10, s[32:35], s91 offen offset:0 lds
    buffer_load_dwordx4 v11, s[32:35], s91 offen offset:1024 lds
    s_add_u32 m0, s89, 106496
    s_lshl_b32 s90, s30, 19
    buffer_load_dwordx4 v14, s[36:39], s90 offen offset:0 lds
    buffer_load_dwordx4 v15, s[36:39], s90 offen offset:1024 lds
    buffer_load_dwordx4 v16, s[36:39], s90 offen offset:2048 lds
    buffer_load_dwordx4 v17, s[36:39], s90 offen offset:3072 lds
    s_add_u32 m0, s88, 81920
    s_lshl_b32 s91, s30, 7
    buffer_load_dwordx4 v10, s[32:35], s91 offen offset:0 lds
    buffer_load_dwordx4 v11, s[32:35], s91 offen offset:1024 lds
    buffer_load_dwordx4 v12, s[32:35], s91 offen offset:2048 lds
    buffer_load_dwordx4 v13, s[32:35], s91 offen offset:3072 lds
    s_add_u32 m0, m0, 4096
    s_add_u32 s91, s91, 40960
    buffer_load_dwordx4 v10, s[32:35], s91 offen offset:0 lds
    buffer_load_dwordx4 v11, s[32:35], s91 offen offset:1024 lds
    s_add_u32 s30, s30, 1
    s_cmp_eq_u32 s30, 9
    s_cselect_b32 s30, 0, s30
    s_lshl_b32 s29, s28, 6
    s_add_u32 s29, s29, s26
    s_mul_i32 s29, s29, 24576
    s_add_u32 s44, s12, s29
    s_addc_u32 s45, s13, 0
    s_mov_b32 s46, 811008
    s_mov_b32 s47, 0x20000
    s_add_u32 s40, s10, s29
    s_addc_u32 s41, s11, 0
    s_mov_b32 s42, 811008
    s_mov_b32 s43, 0x20000
    v_lshlrev_b32 v18, 4, v0
    s_and_b32 s31, s19, 1
    s_lshl_b32 s31, s31, 7
    v_xor_b32 v19, s31, v4
    v_lshl_add_u32 v19, v1, 8, v19
    s_lshl_b32 s93, s19, 10
    v_add_u32 v19, s93, v19
    s_lshl_b32 s31, s19, 2
    v_add_u32 v5, s31, v1
    v_xor_b32 v6, v2, v5
    v_lshlrev_b32 v6, 4, v6
    v_lshl_add_u32 v20, v5, 8, v6
    s_waitcnt vmcnt(10)
    s_barrier
    s_add_u32 m0, s89, 65536
    s_lshl_b32 s90, s30, 19
    buffer_load_dwordx4 v14, s[36:39], s90 offen offset:0 lds
    buffer_load_dwordx4 v15, s[36:39], s90 offen offset:1024 lds
    buffer_load_dwordx4 v16, s[36:39], s90 offen offset:2048 lds
    buffer_load_dwordx4 v17, s[36:39], s90 offen offset:3072 lds
    s_add_u32 m0, s88, 40960
    s_lshl_b32 s91, s30, 7
    buffer_load_dwordx4 v10, s[32:35], s91 offen offset:0 lds
    buffer_load_dwordx4 v11, s[32:35], s91 offen offset:1024 lds
    buffer_load_dwordx4 v12, s[32:35], s91 offen offset:2048 lds
    buffer_load_dwordx4 v13, s[32:35], s91 offen offset:3072 lds
    s_add_u32 m0, m0, 4096
    s_add_u32 s91, s91, 40960
    buffer_load_dwordx4 v10, s[32:35], s91 offen offset:0 lds
    buffer_load_dwordx4 v11, s[32:35], s91 offen offset:1024 lds
    s_add_u32 s30, s30, 1
    s_cmp_eq_u32 s30, 9
    s_cselect_b32 s30, 0, s30
    s_waitcnt vmcnt(10)
    s_barrier
    s_add_u32 m0, s93, 122880
    s_mov_b32 s90, 0
    buffer_load_dwordx4 v20, s[40:43], s90 offen nt lds
    s_add_u32 m0, s93, 126976
    s_mov_b32 s90, 786432
    buffer_load_dwordx4 v20, s[40:43], s90 offen nt lds
    s_add_u32 m0, s93, 131072
    s_mov_b32 s90, 4096
    buffer_load_dwordx4 v20, s[40:43], s90 offen nt lds
    s_add_u32 m0, s93, 135168
    s_mov_b32 s90, 790528
    buffer_load_dwordx4 v20, s[40:43], s90 offen nt lds
    s_add_u32 m0, s93, 139264
    s_mov_b32 s90, 8192
    buffer_load_dwordx4 v20, s[40:43], s90 offen nt lds
    s_add_u32 m0, s93, 143360
    s_mov_b32 s90, 794624
    buffer_load_dwordx4 v20, s[40:43], s90 offen nt lds
    s_add_u32 m0, s89, 24576
    s_lshl_b32 s90, s30, 19
    buffer_load_dwordx4 v14, s[36:39], s90 offen offset:0 lds
    buffer_load_dwordx4 v15, s[36:39], s90 offen offset:1024 lds
    buffer_load_dwordx4 v16, s[36:39], s90 offen offset:2048 lds
    buffer_load_dwordx4 v17, s[36:39], s90 offen offset:3072 lds
    s_add_u32 m0, s88, 0
    s_lshl_b32 s91, s30, 7
    buffer_load_dwordx4 v10, s[32:35], s91 offen offset:0 lds
    buffer_load_dwordx4 v11, s[32:35], s91 offen offset:1024 lds
    buffer_load_dwordx4 v12, s[32:35], s91 offen offset:2048 lds
    buffer_load_dwordx4 v13, s[32:35], s91 offen offset:3072 lds
    s_add_u32 m0, m0, 4096
    s_add_u32 s91, s91, 40960
    buffer_load_dwordx4 v10, s[32:35], s91 offen offset:0 lds
    buffer_load_dwordx4 v11, s[32:35], s91 offen offset:1024 lds
    s_add_u32 s30, s30, 1
    s_cmp_eq_u32 s30, 9
    s_cselect_b32 s30, 0, s30
    s_waitcnt vmcnt(16)
    s_barrier
    s_add_u32 m0, s93, 147456
    s_mov_b32 s90, 12288
    buffer_load_dwordx4 v20, s[40:43], s90 offen nt lds
    s_add_u32 m0, s93, 151552
    s_mov_b32 s90, 798720
    buffer_load_dwordx4 v20, s[40:43], s90 offen nt lds
    s_add_u32 m0, s93, 155648
    s_mov_b32 s90, 16384
    buffer_load_dwordx4 v20, s[40:43], s90 offen nt lds
    s_add_u32 m0, s93, 159744
    s_mov_b32 s90, 802816
    buffer_load_dwordx4 v20, s[40:43], s90 offen nt lds
    s_mov_b32 s90, 0
    buffer_load_dwordx4 v[80:83], v19, s[44:47], s90 offen nt
    s_mov_b32 s90, 4096
    buffer_load_dwordx4 v[84:87], v19, s[44:47], s90 offen nt
    s_mov_b32 s90, 8192
    buffer_load_dwordx4 v[88:91], v19, s[44:47], s90 offen nt
    s_mov_b32 s90, 12288
    buffer_load_dwordx4 v[92:95], v19, s[44:47], s90 offen nt
    s_mov_b32 s90, 16384
    buffer_load_dwordx4 v[96:99], v19, s[44:47], s90 offen nt
    s_mov_b32 s90, 20480
    buffer_load_dwordx4 v[100:103], v19, s[44:47], s90 offen nt
    s_add_u32 m0, s89, 106496
    s_lshl_b32 s90, s30, 19
    buffer_load_dwordx4 v14, s[36:39], s90 offen offset:0 lds
    buffer_load_dwordx4 v15, s[36:39], s90 offen offset:1024 lds
    buffer_load_dwordx4 v16, s[36:39], s90 offen offset:2048 lds
    buffer_load_dwordx4 v17, s[36:39], s90 offen offset:3072 lds
    s_add_u32 m0, s88, 81920
    s_lshl_b32 s91, s30, 7
    buffer_load_dwordx4 v10, s[32:35], s91 offen offset:0 lds
    buffer_load_dwordx4 v11, s[32:35], s91 offen offset:1024 lds
    buffer_load_dwordx4 v12, s[32:35], s91 offen offset:2048 lds
    buffer_load_dwordx4 v13, s[32:35], s91 offen offset:3072 lds
    s_add_u32 m0, m0, 4096
    s_add_u32 s91, s91, 40960
    buffer_load_dwordx4 v10, s[32:35], s91 offen offset:0 lds
    buffer_load_dwordx4 v11, s[32:35], s91 offen offset:1024 lds
    s_add_u32 s30, s30, 1
    s_cmp_eq_u32 s30, 9
    s_cselect_b32 s30, 0, s30
    s_waitcnt vmcnt(20)
    s_barrier
    s_add_u32 m0, s89, 65536
    s_lshl_b32 s90, s30, 19
    buffer_load_dwordx4 v14, s[36:39], s90 offen offset:0 lds
    buffer_load_dwordx4 v15, s[36:39], s90 offen offset:1024 lds
    buffer_load_dwordx4 v16, s[36:39], s90 offen offset:2048 lds
    buffer_load_dwordx4 v17, s[36:39], s90 offen offset:3072 lds
    s_add_u32 m0, s88, 40960
    s_lshl_b32 s91, s30, 7
    buffer_load_dwordx4 v10, s[32:35], s91 offen offset:0 lds
    buffer_load_dwordx4 v11, s[32:35], s91 offen offset:1024 lds
    buffer_load_dwordx4 v12, s[32:35], s91 offen offset:2048 lds
    buffer_load_dwordx4 v13, s[32:35], s91 offen offset:3072 lds
    s_add_u32 m0, m0, 4096
    s_add_u32 s91, s91, 40960
    buffer_load_dwordx4 v10, s[32:35], s91 offen offset:0 lds
    buffer_load_dwordx4 v11, s[32:35], s91 offen offset:1024 lds
    s_add_u32 s30, s30, 1
    s_cmp_eq_u32 s30, 9
    s_cselect_b32 s30, 0, s30
    s_waitcnt vmcnt(10)
    s_barrier
    s_add_u32 m0, s89, 24576
    s_lshl_b32 s90, s30, 19
    buffer_load_dwordx4 v14, s[36:39], s90 offen offset:0 lds
    buffer_load_dwordx4 v15, s[36:39], s90 offen offset:1024 lds
    buffer_load_dwordx4 v16, s[36:39], s90 offen offset:2048 lds
    buffer_load_dwordx4 v17, s[36:39], s90 offen offset:3072 lds
    s_add_u32 m0, s88, 0
    s_lshl_b32 s91, s30, 7
    buffer_load_dwordx4 v10, s[32:35], s91 offen offset:0 lds
    buffer_load_dwordx4 v11, s[32:35], s91 offen offset:1024 lds
    buffer_load_dwordx4 v12, s[32:35], s91 offen offset:2048 lds
    buffer_load_dwordx4 v13, s[32:35], s91 offen offset:3072 lds
    s_add_u32 m0, m0, 4096
    s_add_u32 s91, s91, 40960
    buffer_load_dwordx4 v10, s[32:35], s91 offen offset:0 lds
    buffer_load_dwordx4 v11, s[32:35], s91 offen offset:1024 lds
    s_add_u32 s30, s30, 1
    s_cmp_eq_u32 s30, 9
    s_cselect_b32 s30, 0, s30
    s_waitcnt vmcnt(10)
    s_barrier
    s_add_u32 m0, s89, 106496
    s_lshl_b32 s90, s30, 19
    buffer_load_dwordx4 v14, s[36:39], s90 offen offset:0 lds
    buffer_load_dwordx4 v15, s[36:39], s90 offen offset:1024 lds
    buffer_load_dwordx4 v16, s[36:39], s90 offen offset:2048 lds
    buffer_load_dwordx4 v17, s[36:39], s90 offen offset:3072 lds
    s_add_u32 m0, s88, 81920
    s_lshl_b32 s91, s30, 7
    buffer_load_dwordx4 v10, s[32:35], s91 offen offset:0 lds
    buffer_load_dwordx4 v11, s[32:35], s91 offen offset:1024 lds
    buffer_load_dwordx4 v12, s[32:35], s91 offen offset:2048 lds
    buffer_load_dwordx4 v13, s[32:35], s91 offen offset:3072 lds
    s_add_u32 m0, m0, 4096
    s_add_u32 s91, s91, 40960
    buffer_load_dwordx4 v10, s[32:35], s91 offen offset:0 lds
    buffer_load_dwordx4 v11, s[32:35], s91 offen offset:1024 lds
    s_add_u32 s30, s30, 1
    s_cmp_eq_u32 s30, 9
    s_cselect_b32 s30, 0, s30
    s_waitcnt vmcnt(10)
    s_barrier
    s_add_u32 m0, s89, 65536
    s_lshl_b32 s90, s30, 19
    buffer_load_dwordx4 v14, s[36:39], s90 offen offset:0 lds
    buffer_load_dwordx4 v15, s[36:39], s90 offen offset:1024 lds
    buffer_load_dwordx4 v16, s[36:39], s90 offen offset:2048 lds
    buffer_load_dwordx4 v17, s[36:39], s90 offen offset:3072 lds
    s_add_u32 m0, s88, 40960
    s_lshl_b32 s91, s30, 7
    buffer_load_dwordx4 v10, s[32:35], s91 offen offset:0 lds
    buffer_load_dwordx4 v11, s[32:35], s91 offen offset:1024 lds
    buffer_load_dwordx4 v12, s[32:35], s91 offen offset:2048 lds
    buffer_load_dwordx4 v13, s[32:35], s91 offen offset:3072 lds
    s_add_u32 m0, m0, 4096
    s_add_u32 s91, s91, 40960
    buffer_load_dwordx4 v10, s[32:35], s91 offen offset:0 lds
    buffer_load_dwordx4 v11, s[32:35], s91 offen offset:1024 lds
    s_add_u32 s30, s30, 1
    s_cmp_eq_u32 s30, 9
    s_cselect_b32 s30, 0, s30
    s_waitcnt vmcnt(10)
    s_barrier
    s_add_u32 m0, s89, 24576
    s_lshl_b32 s90, s30, 19
    buffer_load_dwordx4 v14, s[36:39], s90 offen offset:0 lds
    buffer_load_dwordx4 v15, s[36:39], s90 offen offset:1024 lds
    buffer_load_dwordx4 v16, s[36:39], s90 offen offset:2048 lds
    buffer_load_dwordx4 v17, s[36:39], s90 offen offset:3072 lds
    s_add_u32 m0, s88, 0
    s_lshl_b32 s91, s30, 7
    buffer_load_dwordx4 v10, s[32:35], s91 offen offset:0 lds
    buffer_load_dwordx4 v11, s[32:35], s91 offen offset:1024 lds
    buffer_load_dwordx4 v12, s[32:35], s91 offen offset:2048 lds
    buffer_load_dwordx4 v13, s[32:35], s91 offen offset:3072 lds
    s_add_u32 m0, m0, 4096
    s_add_u32 s91, s91, 40960
    buffer_load_dwordx4 v10, s[32:35], s91 offen offset:0 lds
    buffer_load_dwordx4 v11, s[32:35], s91 offen offset:1024 lds
    s_waitcnt vmcnt(10)
    s_barrier
    s_add_u32 m0, s93, 114688
    s_mov_b32 s90, 20480
    buffer_load_dwordx4 v20, s[40:43], s90 offen nt lds
    s_add_u32 m0, s93, 118784
    s_mov_b32 s90, 806912
    buffer_load_dwordx4 v20, s[40:43], s90 offen nt lds
    s_waitcnt vmcnt(2)
    s_barrier
    s_add_u32 m0, s93, 49152
    s_mov_b32 s90, 786432
    buffer_load_dwordx4 v19, s[44:47], s90 offen nt lds
    s_add_u32 m0, s93, 53248
    s_mov_b32 s90, 790528
    buffer_load_dwordx4 v19, s[44:47], s90 offen nt lds
    s_add_u32 m0, s93, 57344
    s_mov_b32 s90, 794624
    buffer_load_dwordx4 v19, s[44:47], s90 offen nt lds
    s_add_u32 m0, s93, 61440
    s_mov_b32 s90, 798720
    buffer_load_dwordx4 v19, s[44:47], s90 offen nt lds
    s_add_u32 m0, s93, 65536
    s_mov_b32 s90, 802816
    buffer_load_dwordx4 v19, s[44:47], s90 offen nt lds
    s_add_u32 m0, s93, 69632
    s_mov_b32 s90, 806912
    buffer_load_dwordx4 v19, s[44:47], s90 offen nt lds
    s_waitcnt vmcnt(6)
    s_barrier
    s_mov_b32 s100, 1
L_HX:
    s_and_b32 s94, s6, 15
    s_mul_i32 s95, s94, 52
    s_lshr_b32 s95, s95, 8
    s_mul_i32 s96, s95, 5
    s_sub_u32 s96, s94, s96
    s_lshr_b32 s98, s6, 4
    s_lshl1_add_u32 s99, s4, s98
    s_lshl_b32 s99, s99, 2
    s_add_u32 s48, s22, 0
    s_addc_u32 s49, s23, 0
    s_mov_b32 s50, 256
    s_mov_b32 s51, 0x20000
    s_lshl_b32 s101, s99, 2
    v_mov_b32 v9, 0
    s_cmp_eq_u32 s94, 15
    s_cbranch_scc1 L_H_NOP2
    buffer_load_dwordx4 v[32:35], v9, s[48:51], s101 offen sc1
    s_mul_i32 s29, s98, 3
    s_add_u32 s29, s29, s95
    s_lshl_b32 s31, s29, 2
    s_lshr_b32 s30, 0xdb8530, s31
    s_mul_i32 s18, s97, 1310720
    s_lshl_b32 s31, s96, 8
    s_add_u32 s18, s18, s31
    s_sub_u32 s31, 5242880, s18
    s_add_u32 s32, s16, s18
    s_addc_u32 s33, s17, 0
    s_mov_b32 s34, s31
    s_mov_b32 s35, 0x20000
    s_mul_i32 s18, s3, 1572864
    s_lshl_b32 s31, s29, 15
    s_add_u32 s18, s18, s31
    s_add_u32 s18, s18, 1044480
    s_add_u32 s36, s24, s18
    s_addc_u32 s37, s25, 0
    s_mov_b32 s38, 1572864
    s_mov_b32 s39, 0x20000
    s_lshl_b32 s31, s19, 4
    v_add_u32 v5, s31, v1
    v_mul_u32_u24 v5, 1280, v5
    v_add_u32 v24, v5, v4
    v_xor_b32 v6, 128, v4
    v_add_u32 v6, v5, v6
    v_add_u32 v25, 4096, v6
    v_add_u32 v26, 8192, v24
    v_add_u32 v27, 12288, v6
    s_add_u32 s90, s30, 0
    s_and_b32 s90, s90, 15
    s_add_u32 m0, s89, 0
    s_mul_i32 s90, s90, 81920
    buffer_load_dwordx4 v24, s[32:35], s90 offen offset:0 lds
    buffer_load_dwordx4 v25, s[32:35], s90 offen offset:1024 lds
    buffer_load_dwordx4 v26, s[32:35], s90 offen offset:2048 lds
    buffer_load_dwordx4 v27, s[32:35], s90 offen offset:3072 lds
    s_add_u32 s90, s30, 1
    s_and_b32 s90, s90, 15
    s_add_u32 m0, s89, 16384
    s_mul_i32 s90, s90, 81920
    buffer_load_dwordx4 v24, s[32:35], s90 offen offset:0 lds
    buffer_load_dwordx4 v25, s[32:35], s90 offen offset:1024 lds
    buffer_load_dwordx4 v26, s[32:35], s90 offen offset:2048 lds
    buffer_load_dwordx4 v27, s[32:35], s90 offen offset:3072 lds
    s_add_u32 s31, s97, 0
    s_and_b32 s31, s31, 3
    s_add_u32 s31, s31, 4
    s_lshl_b32 s31, s31, 10
    s_add_u32 s31, s31, s89
    v_add_u32 v28, s31, v18
    s_add_u32 s31, s97, 1
    s_and_b32 s31, s31, 3
    s_add_u32 s31, s31, 3
    s_lshl_b32 s31, s31, 10
    s_add_u32 s31, s31, s89
    v_add_u32 v29, s31, v18
    s_add_u32 s31, s97, 2
    s_and_b32 s31, s31, 3
    s_add_u32 s31, s31, 2
    s_lshl_b32 s31, s31, 10
    s_add_u32 s31, s31, s89
    v_add_u32 v30, s31, v18
    s_add_u32 s31, s97, 3
    s_and_b32 s31, s31, 3
    s_add_u32 s31, s31, 1
    s_lshl_b32 s31, s31, 10
    s_add_u32 s31, s31, s89
    v_add_u32 v31, s31, v18
    s_and_b32 s88, s19, 1
    s_lshl_b32 s88, s88, 12
    s_cmp_ge_u32 s19, 2
    s_mov_b32 s31, 49152
    s_cselect_b32 s31, 90112, s31
    s_add_u32 s88, s88, s31
    s_waitcnt vmcnt(8)
    s_cmp_eq_u32 s100, 0
    s_cbranch_scc1 L_NOVW0
    s_add_u32 s90, s93, 90112
    v_add_u32 v22, s90, v18
    ds_write_b128 v22, v[80:83] offset:0
    ds_write_b128 v22, v[84:87] offset:4096
    ds_write_b128 v22, v[88:91] offset:8192
    ds_write_b128 v22, v[92:95] offset:12288
    ds_write_b128 v22, v[96:99] offset:16384
    ds_write_b128 v22, v[100:103] offset:20480
L_NOVW0:
    s_waitcnt vmcnt(8) lgkmcnt(0)
    s_mov_b32 s31, 1000000
L_CNT0:
    v_and_b32 v32, v32, v33
    v_and_b32 v34, v34, v35
    v_and_b32 v32, v32, v34
    s_sub_u32 s31, s31, 1
    v_readfirstlane_b32 s29, v32
    s_cbranch_scc1 L_CNTOK0
    s_cmp_eq_u32 s29, 1
    s_cbranch_scc1 L_CNTOK0
    buffer_load_dwordx4 v[32:35], v9, s[48:51], s101 offen sc1
    s_waitcnt vmcnt(0)
    s_branch L_CNT0
L_CNTOK0:
    s_barrier
    s_barrier
    s_add_u32 s90, s30, 2
    s_and_b32 s90, s90, 15
    s_add_u32 m0, s89, 32768
    s_mul_i32 s90, s90, 81920
    buffer_load_dwordx4 v24, s[32:35], s90 offen offset:0 lds
    buffer_load_dwordx4 v25, s[32:35], s90 offen offset:1024 lds
    buffer_load_dwordx4 v26, s[32:35], s90 offen offset:2048 lds
    buffer_load_dwordx4 v27, s[32:35], s90 offen offset:3072 lds
    s_add_u32 s90, s30, 3
    s_and_b32 s90, s90, 15
    s_add_u32 m0, s89, 73728
    s_mul_i32 s90, s90, 81920
    buffer_load_dwordx4 v24, s[32:35], s90 offen offset:0 lds
    buffer_load_dwordx4 v25, s[32:35], s90 offen offset:1024 lds
    buffer_load_dwordx4 v26, s[32:35], s90 offen offset:2048 lds
    buffer_load_dwordx4 v27, s[32:35], s90 offen offset:3072 lds
    s_add_u32 s90, s30, 4
    s_and_b32 s90, s90, 15
    s_add_u32 m0, s89, 114688
    s_mul_i32 s90, s90, 81920
    buffer_load_dwordx4 v24, s[32:35], s90 offen offset:0 lds
    buffer_load_dwordx4 v25, s[32:35], s90 offen offset:1024 lds
    buffer_load_dwordx4 v26, s[32:35], s90 offen offset:2048 lds
    buffer_load_dwordx4 v27, s[32:35], s90 offen offset:3072 lds
    s_add_u32 s90, s30, 5
    s_and_b32 s90, s90, 15
    s_add_u32 m0, s89, 131072
    s_mul_i32 s90, s90, 81920
    buffer_load_dwordx4 v24, s[32:35], s90 offen offset:0 lds
    buffer_load_dwordx4 v25, s[32:35], s90 offen offset:1024 lds
    buffer_load_dwordx4 v26, s[32:35], s90 offen offset:2048 lds
    buffer_load_dwordx4 v27, s[32:35], s90 offen offset:3072 lds
    s_add_u32 s90, s30, 6
    s_and_b32 s90, s90, 15
    s_add_u32 m0, s89, 147456
    s_mul_i32 s90, s90, 81920
    buffer_load_dwordx4 v24, s[32:35], s90 offen offset:0 lds
    buffer_load_dwordx4 v25, s[32:35], s90 offen offset:1024 lds
    buffer_load_dwordx4 v26, s[32:35], s90 offen offset:2048 lds
    buffer_load_dwordx4 v27, s[32:35], s90 offen offset:3072 lds
L_WP2:
    s_add_u32 s90, s30, 0
    s_bfe_u32 s91, s90, 0x30001
    s_and_b32 s90, s90, 1
    s_mul_i32 s91, s91, 196608
    s_lshl_b32 s90, s90, 14
    s_add_u32 m0, s88, 0
    s_add_u32 s90, s90, s91
    s_waitcnt vmcnt(20)
    s_barrier
    buffer_load_dwordx4 v28, s[36:39], s90 offen offset:0 sc1 lds
    buffer_load_dwordx4 v29, s[36:39], s90 offen offset:1024 sc1 lds
    buffer_load_dwordx4 v30, s[36:39], s90 offen offset:2048 sc1 lds
    buffer_load_dwordx4 v31, s[36:39], s90 offen offset:3072 sc1 lds
    s_add_u32 s90, s30, 1
    s_bfe_u32 s91, s90, 0x30001
    s_and_b32 s90, s90, 1
    s_mul_i32 s91, s91, 196608
    s_lshl_b32 s90, s90, 14
    s_add_u32 m0, s88, 8192
    s_add_u32 s90, s90, s91
    buffer_load_dwordx4 v28, s[36:39], s90 offen offset:0 sc1 lds
    buffer_load_dwordx4 v29, s[36:39], s90 offen offset:1024 sc1 lds
    buffer_load_dwordx4 v30, s[36:39], s90 offen offset:2048 sc1 lds
    buffer_load_dwordx4 v31, s[36:39], s90 offen offset:3072 sc1 lds
    s_add_u32 s90, s30, 2
    s_bfe_u32 s91, s90, 0x30001
    s_and_b32 s90, s90, 1
    s_mul_i32 s91, s91, 196608
    s_lshl_b32 s90, s90, 14
    s_add_u32 m0, s88, 16384
    s_add_u32 s90, s90, s91
    s_waitcnt vmcnt(4)
    s_barrier
    buffer_load_dwordx4 v28, s[36:39], s90 offen offset:0 sc1 lds
    buffer_load_dwordx4 v29, s[36:39], s90 offen offset:1024 sc1 lds
    buffer_load_dwordx4 v30, s[36:39], s90 offen offset:2048 sc1 lds
    buffer_load_dwordx4 v31, s[36:39], s90 offen offset:3072 sc1 lds
    s_add_u32 s90, s30, 7
    s_and_b32 s90, s90, 15
    s_add_u32 m0, s89, 0
    s_mul_i32 s90, s90, 81920
    buffer_load_dwordx4 v24, s[32:35], s90 offen offset:0 lds
    buffer_load_dwordx4 v25, s[32:35], s90 offen offset:1024 lds
    s_add_u32 s90, s30, 3
    s_bfe_u32 s91, s90, 0x30001
    s_and_b32 s90, s90, 1
    s_mul_i32 s91, s91, 196608
    s_lshl_b32 s90, s90, 14
    s_add_u32 m0, s88, 0
    s_add_u32 s90, s90, s91
    s_waitcnt vmcnt(6)
    s_barrier
    buffer_load_dwordx4 v28, s[36:39], s90 offen offset:0 sc1 lds
    buffer_load_dwordx4 v29, s[36:39], s90 offen offset:1024 sc1 lds
    buffer_load_dwordx4 v30, s[36:39], s90 offen offset:2048 sc1 lds
    buffer_load_dwordx4 v31, s[36:39], s90 offen offset:3072 sc1 lds
    s_add_u32 s90, s30, 7
    s_and_b32 s90, s90, 15
    s_add_u32 m0, s89, 0
    s_mul_i32 s90, s90, 81920
    buffer_load_dwordx4 v26, s[32:35], s90 offen offset:2048 lds
    buffer_load_dwordx4 v27, s[32:35], s90 offen offset:3072 lds
    s_add_u32 s90, s30, 8
    s_and_b32 s90, s90, 15
    s_add_u32 m0, s89, 16384
    s_mul_i32 s90, s90, 81920
    buffer_load_dwordx4 v24, s[32:35], s90 offen offset:0 lds
    s_add_u32 s90, s30, 4
    s_bfe_u32 s91, s90, 0x30001
    s_and_b32 s90, s90, 1
    s_mul_i32 s91, s91, 196608
    s_lshl_b32 s90, s90, 14
    s_add_u32 m0, s88, 8192
    s_add_u32 s90, s90, s91
    s_waitcnt vmcnt(9)
    s_barrier
    buffer_load_dwordx4 v28, s[36:39], s90 offen offset:0 sc1 lds
    buffer_load_dwordx4 v29, s[36:39], s90 offen offset:1024 sc1 lds
    buffer_load_dwordx4 v30, s[36:39], s90 offen offset:2048 sc1 lds
    buffer_load_dwordx4 v31, s[36:39], s90 offen offset:3072 sc1 lds
    s_add_u32 s90, s30, 8
    s_and_b32 s90, s90, 15
    s_add_u32 m0, s89, 16384
    s_mul_i32 s90, s90, 81920
    buffer_load_dwordx4 v25, s[32:35], s90 offen offset:1024 lds
    buffer_load_dwordx4 v26, s[32:35], s90 offen offset:2048 lds
    buffer_load_dwordx4 v27, s[32:35], s90 offen offset:3072 lds
    s_add_u32 s90, s30, 5
    s_bfe_u32 s91, s90, 0x30001
    s_and_b32 s90, s90, 1
    s_mul_i32 s91, s91, 196608
    s_lshl_b32 s90, s90, 14
    s_add_u32 m0, s88, 16384
    s_add_u32 s90, s90, s91
    s_waitcnt vmcnt(10)
    s_barrier
    buffer_load_dwordx4 v28, s[36:39], s90 offen offset:0 sc1 lds
    buffer_load_dwordx4 v29, s[36:39], s90 offen offset:1024 sc1 lds
    buffer_load_dwordx4 v30, s[36:39], s90 offen offset:2048 sc1 lds
    buffer_load_dwordx4 v31, s[36:39], s90 offen offset:3072 sc1 lds
    s_add_u32 s90, s30, 9
    s_and_b32 s90, s90, 15
    s_add_u32 m0, s89, 32768
    s_mul_i32 s90, s90, 81920
    buffer_load_dwordx4 v24, s[32:35], s90 offen offset:0 lds
    buffer_load_dwordx4 v25, s[32:35], s90 offen offset:1024 lds
    buffer_load_dwordx4 v26, s[32:35], s90 offen offset:2048 lds
    s_add_u32 s90, s30, 6
    s_bfe_u32 s91, s90, 0x30001
    s_and_b32 s90, s90, 1
    s_mul_i32 s91, s91, 196608
    s_lshl_b32 s90, s90, 14
    s_add_u32 m0, s88, 0
    s_add_u32 s90, s90, s91
    s_waitcnt vmcnt(10)
    s_barrier
    buffer_load_dwordx4 v28, s[36:39], s90 offen offset:0 sc1 lds
    buffer_load_dwordx4 v29, s[36:39], s90 offen offset:1024 sc1 lds
    buffer_load_dwordx4 v30, s[36:39], s90 offen offset:2048 sc1 lds
    buffer_load_dwordx4 v31, s[36:39], s90 offen offset:3072 sc1 lds
    s_add_u32 s90, s30, 9
    s_and_b32 s90, s90, 15
    s_add_u32 m0, s89, 32768
    s_mul_i32 s90, s90, 81920
    buffer_load_dwordx4 v27, s[32:35], s90 offen offset:3072 lds
    s_add_u32 s90, s30, 10
    s_and_b32 s90, s90, 15
    s_add_u32 m0, s89, 73728
    s_mul_i32 s90, s90, 81920
    buffer_load_dwordx4 v24, s[32:35], s90 offen offset:0 lds
    buffer_load_dwordx4 v25, s[32:35], s90 offen offset:1024 lds
    s_add_u32 s90, s30, 7
    s_bfe_u32 s91, s90, 0x30001
    s_and_b32 s90, s90, 1
    s_mul_i32 s91, s91, 196608
    s_lshl_b32 s90, s90, 14
    s_add_u32 m0, s88, 8192
    s_add_u32 s90, s90, s91
    s_waitcnt vmcnt(10)
    s_barrier
    buffer_load_dwordx4 v28, s[36:39], s90 offen offset:0 sc1 lds
    buffer_load_dwordx4 v29, s[36:39], s90 offen offset:1024 sc1 lds
    buffer_load_dwordx4 v30, s[36:39], s90 offen offset:2048 sc1 lds
    buffer_load_dwordx4 v31, s[36:39], s90 offen offset:3072 sc1 lds
    s_add_u32 s90, s30, 10
    s_and_b32 s90, s90, 15
    s_add_u32 m0, s89, 73728
    s_mul_i32 s90, s90, 81920
    buffer_load_dwordx4 v26, s[32:35], s90 offen offset:2048 lds
    buffer_load_dwordx4 v27, s[32:35], s90 offen offset:3072 lds
    s_add_u32 s90, s30, 11
    s_and_b32 s90, s90, 15
    s_add_u32 m0, s89, 114688
    s_mul_i32 s90, s90, 81920
    buffer_load_dwordx4 v24, s[32:35], s90 offen offset:0 lds
    s_add_u32 s90, s30, 8
    s_bfe_u32 s91, s90, 0x30001
    s_and_b32 s90, s90, 1
    s_mul_i32 s91, s91, 196608
    s_lshl_b32 s90, s90, 14
    s_add_u32 m0, s88, 16384
    s_add_u32 s90, s90, s91
    s_waitcnt vmcnt(10)
    s_barrier
    buffer_load_dwordx4 v28, s[36:39], s90 offen offset:0 sc1 lds
    buffer_load_dwordx4 v29, s[36:39], s90 offen offset:1024 sc1 lds
    buffer_load_dwordx4 v30, s[36:39], s90 offen offset:2048 sc1 lds
    buffer_load_dwordx4 v31, s[36:39], s90 offen offset:3072 sc1 lds
    s_add_u32 s90, s30, 11
    s_and_b32 s90, s90, 15
    s_add_u32 m0, s89, 114688
    s_mul_i32 s90, s90, 81920
    buffer_load_dwordx4 v25, s[32:35], s90 offen offset:1024 lds
    buffer_load_dwordx4 v26, s[32:35], s90 offen offset:2048 lds
    buffer_load_dwordx4 v27, s[32:35], s90 offen offset:3072 lds
    s_add_u32 s90, s30, 9
    s_bfe_u32 s91, s90, 0x30001
    s_and_b32 s90, s90, 1
    s_mul_i32 s91, s91, 196608
    s_lshl_b32 s90, s90, 14
    s_add_u32 m0, s88, 0
    s_add_u32 s90, s90, s91
    s_waitcnt vmcnt(10)
    s_barrier
    buffer_load_dwordx4 v28, s[36:39], s90 offen offset:0 sc1 lds
    buffer_load_dwordx4 v29, s[36:39], s90 offen offset:1024 sc1 lds
    buffer_load_dwordx4 v30, s[36:39], s90 offen offset:2048 sc1 lds
    buffer_load_dwordx4 v31, s[36:39], s90 offen offset:3072 sc1 lds
    s_add_u32 s90, s30, 12
    s_and_b32 s90, s90, 15
    s_add_u32 m0, s89, 131072
    s_mul_i32 s90, s90, 81920
    buffer_load_dwordx4 v24, s[32:35], s90 offen offset:0 lds
    buffer_load_dwordx4 v25, s[32:35], s90 offen offset:1024 lds
    buffer_load_dwordx4 v26, s[32:35], s90 offen offset:2048 lds
    s_add_u32 s90, s30, 10
    s_bfe_u32 s91, s90, 0x30001
    s_and_b32 s90, s90, 1
    s_mul_i32 s91, s91, 196608
    s_lshl_b32 s90, s90, 14
    s_add_u32 m0, s88, 8192
    s_add_u32 s90, s90, s91
    s_mov_b32 s42, s90
    s_waitcnt vmcnt(10)
    s_barrier
    buffer_load_dwordx4 v29, s[36:39], s90 offen offset:1024 sc1 lds
    buffer_load_dwordx4 v30, s[36:39], s90 offen offset:2048 sc1 lds
    buffer_load_dwordx4 v31, s[36:39], s90 offen offset:3072 sc1 lds
    s_add_u32 s90, s30, 12
    s_and_b32 s90, s90, 15
    s_add_u32 m0, s89, 131072
    s_mul_i32 s90, s90, 81920
    buffer_load_dwordx4 v27, s[32:35], s90 offen offset:3072 lds
    s_add_u32 s90, s30, 13
    s_and_b32 s90, s90, 15
    s_add_u32 m0, s89, 147456
    s_mul_i32 s90, s90, 81920
    buffer_load_dwordx4 v24, s[32:35], s90 offen offset:0 lds
    buffer_load_dwordx4 v25, s[32:35], s90 offen offset:1024 lds
    s_add_u32 s90, s30, 11
    s_bfe_u32 s91, s90, 0x30001
    s_and_b32 s90, s90, 1
    s_mul_i32 s91, s91, 196608
    s_lshl_b32 s90, s90, 14
    s_add_u32 m0, s88, 16384
    s_add_u32 s90, s90, s91
    s_mov_b32 s43, s90
    s_waitcnt vmcnt(9)
    s_barrier
    buffer_load_dwordx4 v29, s[36:39], s90 offen offset:1024 sc1 lds
    buffer_load_dwordx4 v30, s[36:39], s90 offen offset:2048 sc1 lds
    buffer_load_dwordx4 v31, s[36:39], s90 offen offset:3072 sc1 lds
    s_add_u32 s90, s30, 13
    s_and_b32 s90, s90, 15
    s_add_u32 m0, s89, 147456
    s_mul_i32 s90, s90, 81920
    buffer_load_dwordx4 v26, s[32:35], s90 offen offset:2048 lds
    buffer_load_dwordx4 v27, s[32:35], s90 offen offset:3072 lds
    s_add_u32 s90, s30, 14
    s_and_b32 s90, s90, 15
    s_add_u32 m0, s89, 0
    s_mul_i32 s90, s90, 81920
    buffer_load_dwordx4 v24, s[32:35], s90 offen offset:0 lds
    s_add_u32 s90, s30, 12
    s_bfe_u32 s91, s90, 0x30001
    s_and_b32 s90, s90, 1
    s_mul_i32 s91, s91, 196608
    s_lshl_b32 s90, s90, 14
    s_add_u32 m0, s88, 0
    s_add_u32 s90, s90, s91
    s_mov_b32 s44, s90
    s_waitcnt vmcnt(9)
    s_barrier
    buffer_load_dwordx4 v29, s[36:39], s90 offen offset:1024 sc1 lds
    buffer_load_dwordx4 v30, s[36:39], s90 offen offset:2048 sc1 lds
    buffer_load_dwordx4 v31, s[36:39], s90 offen offset:3072 sc1 lds
    s_add_u32 s90, s30, 14
    s_and_b32 s90, s90, 15
    s_add_u32 m0, s89, 0
    s_mul_i32 s90, s90, 81920
    buffer_load_dwordx4 v25, s[32:35], s90 offen offset:1024 lds
    buffer_load_dwordx4 v26, s[32:35], s90 offen offset:2048 lds
    s_add_u32 s90, s30, 13
    s_bfe_u32 s91, s90, 0x30001
    s_and_b32 s90, s90, 1
    s_mul_i32 s91, s91, 196608
    s_lshl_b32 s90, s90, 14
    s_add_u32 m0, s88, 8192
    s_add_u32 s90, s90, s91
    s_mov_b32 s45, s90
    s_waitcnt vmcnt(8)
    s_barrier
    buffer_load_dwordx4 v29, s[36:39], s90 offen offset:1024 sc1 lds
    buffer_load_dwordx4 v30, s[36:39], s90 offen offset:2048 sc1 lds
    buffer_load_dwordx4 v31, s[36:39], s90 offen offset:3072 sc1 lds
    s_add_u32 s90, s30, 14
    s_and_b32 s90, s90, 15
    s_add_u32 m0, s89, 0
    s_mul_i32 s90, s90, 81920
    buffer_load_dwordx4 v27, s[32:35], s90 offen offset:3072 lds
    s_add_u32 s90, s30, 15
    s_and_b32 s90, s90, 15
    s_add_u32 m0, s89, 16384
    s_mul_i32 s90, s90, 81920
    buffer_load_dwordx4 v24, s[32:35], s90 offen offset:0 lds
    s_add_u32 s90, s30, 14
    s_bfe_u32 s91, s90, 0x30001
    s_and_b32 s90, s90, 1
    s_mul_i32 s91, s91, 196608
    s_lshl_b32 s90, s90, 14
    s_add_u32 m0, s88, 16384
    s_add_u32 s90, s90, s91
    s_waitcnt vmcnt(7)
    s_barrier
    buffer_load_dwordx4 v28, s[36:39], s90 offen offset:0 sc1 lds
    buffer_load_dwordx4 v29, s[36:39], s90 offen offset:1024 sc1 lds
    buffer_load_dwordx4 v30, s[36:39], s90 offen offset:2048 sc1 lds
    buffer_load_dwordx4 v31, s[36:39], s90 offen offset:3072 sc1 lds
    s_add_u32 s90, s30, 15
    s_and_b32 s90, s90, 15
    s_add_u32 m0, s89, 16384
    s_mul_i32 s90, s90, 81920
    buffer_load_dwordx4 v25, s[32:35], s90 offen offset:1024 lds
    buffer_load_dwordx4 v26, s[32:35], s90 offen offset:2048 lds
    s_add_u32 s90, s30, 15
    s_bfe_u32 s91, s90, 0x30001
    s_and_b32 s90, s90, 1
    s_mul_i32 s91, s91, 196608
    s_lshl_b32 s90, s90, 14
    s_add_u32 m0, s88, 0
    s_add_u32 s90, s90, s91
    s_waitcnt vmcnt(8)
    s_barrier
    buffer_load_dwordx4 v28, s[36:39], s90 offen offset:0 sc1 lds
    buffer_load_dwordx4 v29, s[36:39], s90 offen offset:1024 sc1 lds
    buffer_load_dwordx4 v30, s[36:39], s90 offen offset:2048 sc1 lds
    buffer_load_dwordx4 v31, s[36:39], s90 offen offset:3072 sc1 lds
    s_add_u32 s90, s30, 15
    s_and_b32 s90, s90, 15
    s_add_u32 m0, s89, 16384
    s_mul_i32 s90, s90, 81920
    buffer_load_dwordx4 v27, s[32:35], s90 offen offset:3072 lds
    s_add_u32 m0, s88, 8192
    s_waitcnt vmcnt(7)
    s_barrier
    buffer_load_dwordx4 v28, s[36:39], s42 offen sc1 lds
    s_add_u32 m0, m0, 1024
    s_nop 0
    buffer_load_dwordx4 v28, s[36:39], s43 offen sc1 lds
    s_add_u32 m0, m0, 1024
    s_nop 0
    buffer_load_dwordx4 v28, s[36:39], s44 offen sc1 lds
    s_add_u32 m0, m0, 1024
    s_nop 0
    buffer_load_dwordx4 v28, s[36:39], s45 offen sc1 lds
    s_waitcnt vmcnt(4)
    s_barrier
    s_waitcnt vmcnt(0)
    s_barrier
    s_branch L_FIN
L_H_NOP2:
    s_cmp_eq_u32 s100, 0
    s_cbranch_scc1 L_NOVW9
    s_add_u32 s90, s93, 90112
    v_add_u32 v22, s90, v18
    ds_write_b128 v22, v[80:83] offset:0
    ds_write_b128 v22, v[84:87] offset:4096
    ds_write_b128 v22, v[88:91] offset:8192
    ds_write_b128 v22, v[92:95] offset:12288
    ds_write_b128 v22, v[96:99] offset:16384
    ds_write_b128 v22, v[100:103] offset:20480
L_NOVW9:
    s_waitcnt vmcnt(0) lgkmcnt(0)
    s_barrier
    s_barrier
    s_branch L_FIN
L_COMPUTE:
    s_setprio 1
    v_mov_b32 v254, v0
    v_lshrrev_b32 v224, 4, v0
    v_and_b32 v225, 15, v0
    v_bfe_u32 v226, v0, 2, 2
    v_and_b32 v227, 3, v0
    s_and_b32 s94, s6, 15
    s_mul_i32 s95, s94, 52
    s_lshr_b32 s95, s95, 8
    s_mul_i32 s96, s95, 5
    s_sub_u32 s96, s94, s96
    s_lshr_b32 s98, s6, 4
    s_lshl1_add_u32 s99, s4, s98
    s_lshl_b32 s99, s99, 2
    s_add_u32 s29, s99, s97
    s_lshl_b32 s101, s29, 2
    s_mul_i32 s43, s29, 16384
    s_lshr_b32 s29, s94, 3
    s_mul_i32 s29, s29, 8192
    s_lshl_b32 s39, s27, 10
    s_add_u32 s39, s39, s29
    s_add_u32 s100, s43, s39
    v_mov_b32 v232, 0
    v_mov_b32 v252, 1
    v_lshlrev_b32 v234, 7, v0
    s_lshl4_add_u32 s93, s7, s94
    s_waitcnt lgkmcnt(0)
    s_add_u32 s44, s24, 0
    s_addc_u32 s45, s25, 0
    s_mov_b32 s46, 262144
    s_mov_b32 s47, 0x20000
    s_add_u32 s48, s22, 0
    s_addc_u32 s49, s23, 0
    s_mov_b32 s50, 256
    s_mov_b32 s51, 0x20000
    s_cmp_lg_u32 s93, 15
    s_cbranch_scc1 L_NOCLR
    s_mov_b32 exec_lo, 0x1f1f1f1f
    s_mov_b32 exec_hi, 0x1f1f1f1f
    s_add_u32 s31, s43, 0
    buffer_store_dword v232, v234, s[44:47], s31 offen sc1
    s_add_u32 s31, s43, 8192
    buffer_store_dword v232, v234, s[44:47], s31 offen sc1
    s_mov_b64 exec, -1
L_NOCLR:
    v_lshl_add_u32 v228, v224, 3, v226
    v_lshlrev_b32 v228, 8, v228
    v_lshl_add_u32 v228, v227, 3, v228
    v_add_u32 v228, 24576, v228
    v_and_b32 v229, 1, v224
    v_lshl_add_u32 v229, v229, 2, v226
    v_xor_b32 v230, 0, v229
    v_lshl_add_u32 v176, v230, 5, v228
    v_xor_b32 v230, 1, v229
    v_lshl_add_u32 v177, v230, 5, v228
    v_xor_b32 v230, 2, v229
    v_lshl_add_u32 v178, v230, 5, v228
    v_xor_b32 v230, 3, v229
    v_lshl_add_u32 v179, v230, 5, v228
    v_xor_b32 v230, 4, v229
    v_lshl_add_u32 v180, v230, 5, v228
    v_xor_b32 v230, 5, v229
    v_lshl_add_u32 v181, v230, 5, v228
    v_xor_b32 v230, 6, v229
    v_lshl_add_u32 v182, v230, 5, v228
    v_xor_b32 v230, 7, v229
    v_lshl_add_u32 v183, v230, 5, v228
    v_and_b32 v230, 6, v225
    v_xor_b32 v230, v230, v224
    v_lshlrev_b32 v230, 4, v230
    v_lshl_add_u32 v230, v225, 7, v230
    s_mul_i32 s29, s7, 6144
    v_add_u32 v184, s29, v230
    v_xor_b32 v185, 64, v184
    s_lshr_b32 s19, s7, 1
    s_lshl_b32 s29, s19, 12
    s_add_u32 s29, s29, 114688
    v_lshrrev_b32 v230, 1, v224
    v_xor_b32 v230, v230, v225
    v_lshlrev_b32 v230, 4, v230
    v_lshl_add_u32 v230, v225, 8, v230
    v_and_b32 v231, 1, v224
    v_lshl_add_u32 v230, v231, 3, v230
    v_add_u32 v186, s29, v230
    v_lshrrev_b32 v230, 2, v0
    v_and_b32 v231, 7, v230
    v_lshlrev_b32 v230, 8, v230
    v_lshl_add_u32 v230, v231, 5, v230
    v_lshl_add_u32 v230, v227, 3, v230
    s_cmp_eq_u32 s19, 0
    s_mov_b32 s29, 49152
    s_cselect_b32 s29, 90112, s29
    v_add_u32 v191, s29, v230
    v_lshlrev_b32 v190, 4, v0
    s_lshl_b32 s30, s7, 7
    v_lshl_add_u32 v253, v0, 13, s30
    v_mov_b32 v0, 0
    v_mov_b32 v1, 0
    v_mov_b32 v2, 0
    v_mov_b32 v3, 0
    v_mov_b32 v4, 0
    v_mov_b32 v5, 0
    v_mov_b32 v6, 0
    v_mov_b32 v7, 0
    v_mov_b32 v8, 0
    v_mov_b32 v9, 0
    v_mov_b32 v10, 0
    v_mov_b32 v11, 0
    v_mov_b32 v12, 0
    v_mov_b32 v13, 0
    v_mov_b32 v14, 0
    v_mov_b32 v15, 0
    v_mov_b32 v16, 0
    v_mov_b32 v17, 0
    v_mov_b32 v18, 0
    v_mov_b32 v19, 0
    v_mov_b32 v20, 0
    v_mov_b32 v21, 0
    v_mov_b32 v22, 0
    v_mov_b32 v23, 0
    v_mov_b32 v24, 0
    v_mov_b32 v25, 0
    v_mov_b32 v26, 0
    v_mov_b32 v27, 0
    v_mov_b32 v28, 0
    v_mov_b32 v29, 0
    v_mov_b32 v30, 0
    v_mov_b32 v31, 0
    v_mov_b32 v32, 0
    v_mov_b32 v33, 0
    v_mov_b32 v34, 0
    v_mov_b32 v35, 0
    v_mov_b32 v36, 0
    v_mov_b32 v37, 0
    v_mov_b32 v38, 0
    v_mov_b32 v39, 0
    v_mov_b32 v40, 0
    v_mov_b32 v41, 0
    v_mov_b32 v42, 0
    v_mov_b32 v43, 0
    v_mov_b32 v44, 0
    v_mov_b32 v45, 0
    v_mov_b32 v46, 0
    v_mov_b32 v47, 0
    v_mov_b32 v48, 0
    v_mov_b32 v49, 0
    v_mov_b32 v50, 0
    v_mov_b32 v51, 0
    v_mov_b32 v52, 0
    v_mov_b32 v53, 0
    v_mov_b32 v54, 0
    v_mov_b32 v55, 0
    v_mov_b32 v56, 0
    v_mov_b32 v57, 0
    v_mov_b32 v58, 0
    v_mov_b32 v59, 0
    v_mov_b32 v60, 0
    v_mov_b32 v61, 0
    v_mov_b32 v62, 0
    v_mov_b32 v63, 0
    v_mov_b32 v64, 0
    v_mov_b32 v65, 0
    v_mov_b32 v66, 0
    v_mov_b32 v67, 0
    v_mov_b32 v68, 0
    v_mov_b32 v69, 0
    v_mov_b32 v70, 0
    v_mov_b32 v71, 0
    v_mov_b32 v72, 0
    v_mov_b32 v73, 0
    v_mov_b32 v74, 0
    v_mov_b32 v75, 0
    v_mov_b32 v76, 0
    v_mov_b32 v77, 0
    v_mov_b32 v78, 0
    v_mov_b32 v79, 0
    v_mov_b32 v80, 0
    v_mov_b32 v81, 0
    v_mov_b32 v82, 0
    v_mov_b32 v83, 0
    v_mov_b32 v84, 0
    v_mov_b32 v85, 0
    v_mov_b32 v86, 0
    v_mov_b32 v87, 0
    v_mov_b32 v88, 0
    v_mov_b32 v89, 0
    v_mov_b32 v90, 0
    v_mov_b32 v91, 0
    v_mov_b32 v92, 0
    v_mov_b32 v93, 0
    v_mov_b32 v94, 0
    v_mov_b32 v95, 0
    s_lshl_b32 s29, s4, 5
    s_add_u32 s29, s29, s26
    s_mul_i32 s29, s29, 196608
    s_add_u32 s29, s29, 1048576
    s_add_u32 s32, s24, s29
    s_addc_u32 s33, s25, 0
    s_mov_b32 s34, 196608
    s_mov_b32 s35, 0x20000
    s_mul_i32 s29, s28, 12
    s_mul_i32 s31, s7, 3
    s_add_u32 s29, s29, s31
    s_add_u32 s31, s29, 0
    s_lshr_b32 s18, s31, 3
    s_lshl_b32 s18, s18, 15
    s_and_b32 s31, s31, 7
    s_lshl_b32 s31, s31, 10
    s_add_u32 s40, s31, s18
    s_add_u32 s31, s29, 1
    s_lshr_b32 s18, s31, 3
    s_lshl_b32 s18, s18, 15
    s_and_b32 s31, s31, 7
    s_lshl_b32 s31, s31, 10
    s_add_u32 s41, s31, s18
    s_add_u32 s31, s29, 2
    s_lshr_b32 s18, s31, 3
    s_lshl_b32 s18, s18, 15
    s_and_b32 s31, s31, 7
    s_lshl_b32 s31, s31, 10
    s_add_u32 s42, s31, s18
    s_mul_i32 s18, s99, 16384
    s_add_u32 s18, s18, s39
    s_add_u32 s18, s18, s30
    s_add_u32 s18, s18, 128
    s_add_u32 s8, s24, s18
    s_addc_u32 s9, s25, 0
    s_lshl_b32 s18, s7, 11
    s_add_u32 s18, s18, s43
    s_add_u32 s10, s24, s18
    s_addc_u32 s11, s25, 0
    s_cmp_eq_u32 s95, 2
    s_cselect_b32 s12, 8192, 0
    s_cmp_lg_u32 s93, 15
    s_cbranch_scc1 L_NOCLR2
    s_waitcnt vmcnt(0)
    s_mov_b64 exec, 1
    buffer_store_dword v252, v232, s[48:51], s101 offen sc1
    s_mov_b64 exec, -1
L_NOCLR2:
    s_mov_b32 s29, 0
    s_mov_b32 s88, 81920
    s_mov_b32 s89, 4294926336
    s_mov_b32 s90, s89
    s_barrier
    ds_read_b64_tr_b16 v[96:97], v176 offset:0
    ds_read_b64_tr_b16 v[98:99], v176 offset:1024
    ds_read_b128 v[128:131], v184 offset:0
    ds_read_b64_tr_b16 v[100:101], v176 offset:8192
    ds_read_b64_tr_b16 v[102:103], v176 offset:9216
    ds_read_b128 v[132:135], v185 offset:0
    ds_read_b128 v[136:139], v184 offset:2048
    ds_read_b128 v[140:143], v185 offset:2048
    ds_read_b128 v[144:147], v184 offset:4096
    ds_read_b128 v[148:151], v185 offset:4096
    ds_read_b64_tr_b16 v[104:105], v177 offset:0
    ds_read_b64_tr_b16 v[106:107], v177 offset:1024
    ds_read_b64_tr_b16 v[108:109], v177 offset:8192
    ds_read_b64_tr_b16 v[110:111], v177 offset:9216
L_QLOOP:
    s_waitcnt lgkmcnt(8)
    v_mfma_f32_16x16x32_bf16 v[0:3], v[96:99], v[128:131], v[0:3]
    ds_read_b64_tr_b16 v[112:113], v178 offset:0
    v_mfma_f32_16x16x32_bf16 v[0:3], v[100:103], v[132:135], v[0:3]
    ds_read_b64_tr_b16 v[114:115], v178 offset:1024
    s_waitcnt lgkmcnt(6)
    v_mfma_f32_16x16x32_bf16 v[4:7], v[100:103], v[140:143], v[4:7]
    ds_read_b64_tr_b16 v[116:117], v178 offset:8192
    v_mfma_f32_16x16x32_bf16 v[4:7], v[96:99], v[136:139], v[4:7]
    ds_read_b64_tr_b16 v[118:119], v178 offset:9216
    v_mfma_f32_16x16x32_bf16 v[8:11], v[96:99], v[144:147], v[8:11]
    ds_read_b64_tr_b16 v[120:121], v179 offset:0
    v_mfma_f32_16x16x32_bf16 v[8:11], v[100:103], v[148:151], v[8:11]
    ds_read_b64_tr_b16 v[122:123], v179 offset:1024
    s_waitcnt lgkmcnt(6)
    v_mfma_f32_16x16x32_bf16 v[20:23], v[108:111], v[148:151], v[20:23]
    ds_read_b64_tr_b16 v[124:125], v179 offset:8192
    v_mfma_f32_16x16x32_bf16 v[20:23], v[104:107], v[144:147], v[20:23]
    ds_read_b64_tr_b16 v[126:127], v179 offset:9216
    v_mfma_f32_16x16x32_bf16 v[16:19], v[104:107], v[136:139], v[16:19]
    ds_read_b64_tr_b16 v[96:97], v180 offset:0
    v_mfma_f32_16x16x32_bf16 v[16:19], v[108:111], v[140:143], v[16:19]
    ds_read_b64_tr_b16 v[98:99], v180 offset:1024
    v_mfma_f32_16x16x32_bf16 v[12:15], v[108:111], v[132:135], v[12:15]
    ds_read_b64_tr_b16 v[100:101], v180 offset:8192
    v_mfma_f32_16x16x32_bf16 v[12:15], v[104:107], v[128:131], v[12:15]
    ds_read_b64_tr_b16 v[102:103], v180 offset:9216
    s_waitcnt lgkmcnt(8)
    v_mfma_f32_16x16x32_bf16 v[24:27], v[112:115], v[128:131], v[24:27]
    ds_read_b64_tr_b16 v[104:105], v181 offset:0
    v_mfma_f32_16x16x32_bf16 v[24:27], v[116:119], v[132:135], v[24:27]
    ds_read_b64_tr_b16 v[106:107], v181 offset:1024
    v_mfma_f32_16x16x32_bf16 v[28:31], v[116:119], v[140:143], v[28:31]
    ds_read_b64_tr_b16 v[108:109], v181 offset:8192
    v_mfma_f32_16x16x32_bf16 v[28:31], v[112:115], v[136:139], v[28:31]
    ds_read_b64_tr_b16 v[110:111], v181 offset:9216
    v_mfma_f32_16x16x32_bf16 v[32:35], v[112:115], v[144:147], v[32:35]
    s_mov_b32 s30, s88
    s_mov_b32 s88, s89
    v_mfma_f32_16x16x32_bf16 v[32:35], v[116:119], v[148:151], v[32:35]
    s_mov_b32 s89, s90
    s_mov_b32 s90, s30
    s_waitcnt lgkmcnt(8)
    v_mfma_f32_16x16x32_bf16 v[44:47], v[124:127], v[148:151], v[44:47]
    ds_read_b64_tr_b16 v[112:113], v182 offset:0
    v_mfma_f32_16x16x32_bf16 v[44:47], v[120:123], v[144:147], v[44:47]
    ds_read_b64_tr_b16 v[114:115], v182 offset:1024
    v_mfma_f32_16x16x32_bf16 v[40:43], v[120:123], v[136:139], v[40:43]
    ds_read_b64_tr_b16 v[116:117], v182 offset:8192
    v_mfma_f32_16x16x32_bf16 v[40:43], v[124:127], v[140:143], v[40:43]
    ds_read_b64_tr_b16 v[118:119], v182 offset:9216
    v_mfma_f32_16x16x32_bf16 v[36:39], v[124:127], v[132:135], v[36:39]
    s_add_u32 s29, s29, 1
    v_mfma_f32_16x16x32_bf16 v[36:39], v[120:123], v[128:131], v[36:39]
    s_cmp_eq_u32 s29, 5
    s_waitcnt lgkmcnt(8)
    v_mfma_f32_16x16x32_bf16 v[48:51], v[96:99], v[128:131], v[48:51]
    ds_read_b64_tr_b16 v[120:121], v183 offset:0
    v_mfma_f32_16x16x32_bf16 v[48:51], v[100:103], v[132:135], v[48:51]
    ds_read_b64_tr_b16 v[122:123], v183 offset:1024
    v_mfma_f32_16x16x32_bf16 v[52:55], v[100:103], v[140:143], v[52:55]
    ds_read_b64_tr_b16 v[124:125], v183 offset:8192
    v_mfma_f32_16x16x32_bf16 v[52:55], v[96:99], v[136:139], v[52:55]
    ds_read_b64_tr_b16 v[126:127], v183 offset:9216
    v_mfma_f32_16x16x32_bf16 v[56:59], v[96:99], v[144:147], v[56:59]
    v_add_u32 v176, s30, v176
    v_add_u32 v177, s30, v177
    v_mfma_f32_16x16x32_bf16 v[56:59], v[100:103], v[148:151], v[56:59]
    v_add_u32 v178, s30, v178
    v_add_u32 v179, s30, v179
    s_waitcnt lgkmcnt(8)
    v_mfma_f32_16x16x32_bf16 v[68:71], v[108:111], v[148:151], v[68:71]
    v_add_u32 v180, s30, v180
    v_add_u32 v181, s30, v181
    v_mfma_f32_16x16x32_bf16 v[68:71], v[104:107], v[144:147], v[68:71]
    v_add_u32 v182, s30, v182
    v_add_u32 v183, s30, v183
    v_mfma_f32_16x16x32_bf16 v[64:67], v[104:107], v[136:139], v[64:67]
    v_add_u32 v184, s30, v184
    v_add_u32 v185, s30, v185
    v_mfma_f32_16x16x32_bf16 v[64:67], v[108:111], v[140:143], v[64:67]
    s_waitcnt lgkmcnt(0)
    s_barrier
    v_mfma_f32_16x16x32_bf16 v[60:63], v[108:111], v[132:135], v[60:63]
    ds_read_b64_tr_b16 v[96:97], v176 offset:0
    v_mfma_f32_16x16x32_bf16 v[60:63], v[104:107], v[128:131], v[60:63]
    ds_read_b64_tr_b16 v[98:99], v176 offset:1024
    v_mfma_f32_16x16x32_bf16 v[72:75], v[112:115], v[128:131], v[72:75]
    ds_read_b128 v[152:155], v184 offset:0
    v_mfma_f32_16x16x32_bf16 v[72:75], v[116:119], v[132:135], v[72:75]
    ds_read_b64_tr_b16 v[100:101], v176 offset:8192
    v_mfma_f32_16x16x32_bf16 v[76:79], v[116:119], v[140:143], v[76:79]
    ds_read_b64_tr_b16 v[102:103], v176 offset:9216
    v_mfma_f32_16x16x32_bf16 v[76:79], v[112:115], v[136:139], v[76:79]
    ds_read_b128 v[156:159], v185 offset:0
    v_mfma_f32_16x16x32_bf16 v[80:83], v[112:115], v[144:147], v[80:83]
    ds_read_b128 v[160:163], v184 offset:2048
    v_mfma_f32_16x16x32_bf16 v[80:83], v[116:119], v[148:151], v[80:83]
    ds_read_b128 v[164:167], v185 offset:2048
    v_mfma_f32_16x16x32_bf16 v[92:95], v[124:127], v[148:151], v[92:95]
    ds_read_b128 v[168:171], v184 offset:4096
    v_mfma_f32_16x16x32_bf16 v[92:95], v[120:123], v[144:147], v[92:95]
    ds_read_b128 v[172:175], v185 offset:4096
    v_mfma_f32_16x16x32_bf16 v[88:91], v[120:123], v[136:139], v[88:91]
    ds_read_b64_tr_b16 v[104:105], v177 offset:0
    v_mfma_f32_16x16x32_bf16 v[88:91], v[124:127], v[140:143], v[88:91]
    ds_read_b64_tr_b16 v[106:107], v177 offset:1024
    v_mfma_f32_16x16x32_bf16 v[84:87], v[124:127], v[132:135], v[84:87]
    ds_read_b64_tr_b16 v[108:109], v177 offset:8192
    v_mfma_f32_16x16x32_bf16 v[84:87], v[120:123], v[128:131], v[84:87]
    ds_read_b64_tr_b16 v[110:111], v177 offset:9216
    s_cbranch_scc1 L_QDONE
    s_waitcnt lgkmcnt(8)
    v_mfma_f32_16x16x32_bf16 v[0:3], v[96:99], v[152:155], v[0:3]
    ds_read_b64_tr_b16 v[112:113], v178 offset:0
    v_mfma_f32_16x16x32_bf16 v[0:3], v[100:103], v[156:159], v[0:3]
    ds_read_b64_tr_b16 v[114:115], v178 offset:1024
    s_waitcnt lgkmcnt(6)
    v_mfma_f32_16x16x32_bf16 v[4:7], v[100:103], v[164:167], v[4:7]
    ds_read_b64_tr_b16 v[116:117], v178 offset:8192
    v_mfma_f32_16x16x32_bf16 v[4:7], v[96:99], v[160:163], v[4:7]
    ds_read_b64_tr_b16 v[118:119], v178 offset:9216
    v_mfma_f32_16x16x32_bf16 v[8:11], v[96:99], v[168:171], v[8:11]
    ds_read_b64_tr_b16 v[120:121], v179 offset:0
    v_mfma_f32_16x16x32_bf16 v[8:11], v[100:103], v[172:175], v[8:11]
    ds_read_b64_tr_b16 v[122:123], v179 offset:1024
    s_waitcnt lgkmcnt(6)
    v_mfma_f32_16x16x32_bf16 v[20:23], v[108:111], v[172:175], v[20:23]
    ds_read_b64_tr_b16 v[124:125], v179 offset:8192
    v_mfma_f32_16x16x32_bf16 v[20:23], v[104:107], v[168:171], v[20:23]
    ds_read_b64_tr_b16 v[126:127], v179 offset:9216
    v_mfma_f32_16x16x32_bf16 v[16:19], v[104:107], v[160:163], v[16:19]
    ds_read_b64_tr_b16 v[96:97], v180 offset:0
    v_mfma_f32_16x16x32_bf16 v[16:19], v[108:111], v[164:167], v[16:19]
    ds_read_b64_tr_b16 v[98:99], v180 offset:1024
    v_mfma_f32_16x16x32_bf16 v[12:15], v[108:111], v[156:159], v[12:15]
    ds_read_b64_tr_b16 v[100:101], v180 offset:8192
    v_mfma_f32_16x16x32_bf16 v[12:15], v[104:107], v[152:155], v[12:15]
    ds_read_b64_tr_b16 v[102:103], v180 offset:9216
    s_waitcnt lgkmcnt(8)
    v_mfma_f32_16x16x32_bf16 v[24:27], v[112:115], v[152:155], v[24:27]
    ds_read_b64_tr_b16 v[104:105], v181 offset:0
    v_mfma_f32_16x16x32_bf16 v[24:27], v[116:119], v[156:159], v[24:27]
    ds_read_b64_tr_b16 v[106:107], v181 offset:1024
    v_mfma_f32_16x16x32_bf16 v[28:31], v[116:119], v[164:167], v[28:31]
    ds_read_b64_tr_b16 v[108:109], v181 offset:8192
    v_mfma_f32_16x16x32_bf16 v[28:31], v[112:115], v[160:163], v[28:31]
    ds_read_b64_tr_b16 v[110:111], v181 offset:9216
    v_mfma_f32_16x16x32_bf16 v[32:35], v[112:115], v[168:171], v[32:35]
    s_mov_b32 s30, s88
    s_mov_b32 s88, s89
    v_mfma_f32_16x16x32_bf16 v[32:35], v[116:119], v[172:175], v[32:35]
    s_mov_b32 s89, s90
    s_mov_b32 s90, s30
    s_waitcnt lgkmcnt(8)
    v_mfma_f32_16x16x32_bf16 v[44:47], v[124:127], v[172:175], v[44:47]
    ds_read_b64_tr_b16 v[112:113], v182 offset:0
    v_mfma_f32_16x16x32_bf16 v[44:47], v[120:123], v[168:171], v[44:47]
    ds_read_b64_tr_b16 v[114:115], v182 offset:1024
    v_mfma_f32_16x16x32_bf16 v[40:43], v[120:123], v[160:163], v[40:43]
    ds_read_b64_tr_b16 v[116:117], v182 offset:8192
    v_mfma_f32_16x16x32_bf16 v[40:43], v[124:127], v[164:167], v[40:43]
    ds_read_b64_tr_b16 v[118:119], v182 offset:9216
    v_mfma_f32_16x16x32_bf16 v[36:39], v[124:127], v[156:159], v[36:39]
    v_mfma_f32_16x16x32_bf16 v[36:39], v[120:123], v[152:155], v[36:39]
    s_waitcnt lgkmcnt(8)
    v_mfma_f32_16x16x32_bf16 v[48:51], v[96:99], v[152:155], v[48:51]
    ds_read_b64_tr_b16 v[120:121], v183 offset:0
    v_mfma_f32_16x16x32_bf16 v[48:51], v[100:103], v[156:159], v[48:51]
    ds_read_b64_tr_b16 v[122:123], v183 offset:1024
    v_mfma_f32_16x16x32_bf16 v[52:55], v[100:103], v[164:167], v[52:55]
    ds_read_b64_tr_b16 v[124:125], v183 offset:8192
    v_mfma_f32_16x16x32_bf16 v[52:55], v[96:99], v[160:163], v[52:55]
    ds_read_b64_tr_b16 v[126:127], v183 offset:9216
    v_mfma_f32_16x16x32_bf16 v[56:59], v[96:99], v[168:171], v[56:59]
    v_add_u32 v176, s30, v176
    v_add_u32 v177, s30, v177
    v_mfma_f32_16x16x32_bf16 v[56:59], v[100:103], v[172:175], v[56:59]
    v_add_u32 v178, s30, v178
    v_add_u32 v179, s30, v179
    s_waitcnt lgkmcnt(8)
    v_mfma_f32_16x16x32_bf16 v[68:71], v[108:111], v[172:175], v[68:71]
    v_add_u32 v180, s30, v180
    v_add_u32 v181, s30, v181
    v_mfma_f32_16x16x32_bf16 v[68:71], v[104:107], v[168:171], v[68:71]
    v_add_u32 v182, s30, v182
    v_add_u32 v183, s30, v183
    v_mfma_f32_16x16x32_bf16 v[64:67], v[104:107], v[160:163], v[64:67]
    v_add_u32 v184, s30, v184
    v_add_u32 v185, s30, v185
    v_mfma_f32_16x16x32_bf16 v[64:67], v[108:111], v[164:167], v[64:67]
    s_waitcnt lgkmcnt(0)
    s_barrier
    v_mfma_f32_16x16x32_bf16 v[60:63], v[108:111], v[156:159], v[60:63]
    ds_read_b64_tr_b16 v[96:97], v176 offset:0
    v_mfma_f32_16x16x32_bf16 v[60:63], v[104:107], v[152:155], v[60:63]
    ds_read_b64_tr_b16 v[98:99], v176 offset:1024
    v_mfma_f32_16x16x32_bf16 v[72:75], v[112:115], v[152:155], v[72:75]
    ds_read_b128 v[128:131], v184 offset:0
    v_mfma_f32_16x16x32_bf16 v[72:75], v[116:119], v[156:159], v[72:75]
    ds_read_b64_tr_b16 v[100:101], v176 offset:8192
    v_mfma_f32_16x16x32_bf16 v[76:79], v[116:119], v[164:167], v[76:79]
    ds_read_b64_tr_b16 v[102:103], v176 offset:9216
    v_mfma_f32_16x16x32_bf16 v[76:79], v[112:115], v[160:163], v[76:79]
    ds_read_b128 v[132:135], v185 offset:0
    v_mfma_f32_16x16x32_bf16 v[80:83], v[112:115], v[168:171], v[80:83]
    ds_read_b128 v[136:139], v184 offset:2048
    v_mfma_f32_16x16x32_bf16 v[80:83], v[116:119], v[172:175], v[80:83]
    ds_read_b128 v[140:143], v185 offset:2048
    v_mfma_f32_16x16x32_bf16 v[92:95], v[124:127], v[172:175], v[92:95]
    ds_read_b128 v[144:147], v184 offset:4096
    v_mfma_f32_16x16x32_bf16 v[92:95], v[120:123], v[168:171], v[92:95]
    ds_read_b128 v[148:151], v185 offset:4096
    v_mfma_f32_16x16x32_bf16 v[88:91], v[120:123], v[160:163], v[88:91]
    ds_read_b64_tr_b16 v[104:105], v177 offset:0
    v_mfma_f32_16x16x32_bf16 v[88:91], v[124:127], v[164:167], v[88:91]
    ds_read_b64_tr_b16 v[106:107], v177 offset:1024
    v_mfma_f32_16x16x32_bf16 v[84:87], v[124:127], v[156:159], v[84:87]
    ds_read_b64_tr_b16 v[108:109], v177 offset:8192
    v_mfma_f32_16x16x32_bf16 v[84:87], v[120:123], v[152:155], v[84:87]
    ds_read_b64_tr_b16 v[110:111], v177 offset:9216
    s_branch L_QLOOP
L_QDONE:
    s_waitcnt lgkmcnt(8)
    v_mfma_f32_16x16x32_bf16 v[0:3], v[96:99], v[152:155], v[0:3]
    ds_read_b64_tr_b16 v[112:113], v178 offset:0
    v_mfma_f32_16x16x32_bf16 v[0:3], v[100:103], v[156:159], v[0:3]
    ds_read_b64_tr_b16 v[114:115], v178 offset:1024
    s_waitcnt lgkmcnt(6)
    v_mfma_f32_16x16x32_bf16 v[4:7], v[100:103], v[164:167], v[4:7]
    ds_read_b64_tr_b16 v[116:117], v178 offset:8192
    v_mfma_f32_16x16x32_bf16 v[4:7], v[96:99], v[160:163], v[4:7]
    ds_read_b64_tr_b16 v[118:119], v178 offset:9216
    v_mfma_f32_16x16x32_bf16 v[8:11], v[96:99], v[168:171], v[8:11]
    ds_read_b64_tr_b16 v[120:121], v179 offset:0
    v_xor_b32 v176, 0, v186
    v_mfma_f32_16x16x32_bf16 v[8:11], v[100:103], v[172:175], v[8:11]
    ds_read_b64_tr_b16 v[122:123], v179 offset:1024
    v_xor_b32 v177, 32, v186
    s_waitcnt lgkmcnt(6)
    v_mfma_f32_16x16x32_bf16 v[12:15], v[108:111], v[156:159], v[12:15]
    ds_read_b64_tr_b16 v[124:125], v179 offset:8192
    v_mfma_f32_16x16x32_bf16 v[12:15], v[104:107], v[152:155], v[12:15]
    ds_read_b64_tr_b16 v[126:127], v179 offset:9216
    v_mfma_f32_16x16x32_bf16 v[16:19], v[104:107], v[160:163], v[16:19]
    ds_read_b64_tr_b16 v[96:97], v180 offset:0
    v_xor_b32 v178, 64, v186
    v_mfma_f32_16x16x32_bf16 v[16:19], v[108:111], v[164:167], v[16:19]
    ds_read_b64_tr_b16 v[98:99], v180 offset:1024
    v_xor_b32 v179, 96, v186
    v_mfma_f32_16x16x32_bf16 v[20:23], v[108:111], v[172:175], v[20:23]
    ds_read_b64_tr_b16 v[100:101], v180 offset:8192
    v_mfma_f32_16x16x32_bf16 v[20:23], v[104:107], v[168:171], v[20:23]
    ds_read_b64_tr_b16 v[102:103], v180 offset:9216
    s_waitcnt lgkmcnt(8)
    v_mfma_f32_16x16x32_bf16 v[24:27], v[112:115], v[152:155], v[24:27]
    ds_read_b64_tr_b16 v[104:105], v181 offset:0
    v_xor_b32 v180, 128, v186
    v_mfma_f32_16x16x32_bf16 v[24:27], v[116:119], v[156:159], v[24:27]
    ds_read_b64_tr_b16 v[106:107], v181 offset:1024
    v_mfma_f32_16x16x32_bf16 v[28:31], v[116:119], v[164:167], v[28:31]
    ds_read_b64_tr_b16 v[108:109], v181 offset:8192
    v_mfma_f32_16x16x32_bf16 v[28:31], v[112:115], v[160:163], v[28:31]
    ds_read_b64_tr_b16 v[110:111], v181 offset:9216
    v_mfma_f32_16x16x32_bf16 v[32:35], v[112:115], v[168:171], v[32:35]
    v_xor_b32 v181, 160, v186
    v_cvt_pk_bf16_f32 v0, v0, v1
    v_mfma_f32_16x16x32_bf16 v[32:35], v[116:119], v[172:175], v[32:35]
    v_cvt_pk_bf16_f32 v1, v2, v3
    v_cvt_pk_bf16_f32 v2, v12, v13
    s_waitcnt lgkmcnt(8)
    v_mfma_f32_16x16x32_bf16 v[36:39], v[124:127], v[156:159], v[36:39]
    ds_read_b64_tr_b16 v[112:113], v182 offset:0
    v_cvt_pk_bf16_f32 v3, v14, v15
    v_mfma_f32_16x16x32_bf16 v[36:39], v[120:123], v[152:155], v[36:39]
    ds_read_b64_tr_b16 v[114:115], v182 offset:1024
    v_cvt_pk_bf16_f32 v4, v4, v5
    v_mfma_f32_16x16x32_bf16 v[40:43], v[120:123], v[160:163], v[40:43]
    ds_read_b64_tr_b16 v[116:117], v182 offset:8192
    v_cvt_pk_bf16_f32 v5, v6, v7
    v_mfma_f32_16x16x32_bf16 v[40:43], v[124:127], v[164:167], v[40:43]
    ds_read_b64_tr_b16 v[118:119], v182 offset:9216
    v_cvt_pk_bf16_f32 v6, v16, v17
    v_mfma_f32_16x16x32_bf16 v[44:47], v[124:127], v[172:175], v[44:47]
    v_xor_b32 v182, 192, v186
    v_cvt_pk_bf16_f32 v7, v18, v19
    v_mfma_f32_16x16x32_bf16 v[44:47], v[120:123], v[168:171], v[44:47]
    v_cvt_pk_bf16_f32 v8, v8, v9
    v_cvt_pk_bf16_f32 v9, v10, v11
    s_waitcnt lgkmcnt(8)
    v_mfma_f32_16x16x32_bf16 v[48:51], v[96:99], v[152:155], v[48:51]
    ds_read_b64_tr_b16 v[120:121], v183 offset:0
    v_cvt_pk_bf16_f32 v10, v20, v21
    v_mfma_f32_16x16x32_bf16 v[48:51], v[100:103], v[156:159], v[48:51]
    ds_read_b64_tr_b16 v[122:123], v183 offset:1024
    v_cvt_pk_bf16_f32 v11, v22, v23
    v_mfma_f32_16x16x32_bf16 v[52:55], v[100:103], v[164:167], v[52:55]
    ds_read_b64_tr_b16 v[124:125], v183 offset:8192
    v_cvt_pk_bf16_f32 v24, v24, v25
    v_mfma_f32_16x16x32_bf16 v[52:55], v[96:99], v[160:163], v[52:55]
    ds_read_b64_tr_b16 v[126:127], v183 offset:9216
    v_cvt_pk_bf16_f32 v25, v26, v27
    v_mfma_f32_16x16x32_bf16 v[56:59], v[96:99], v[168:171], v[56:59]
    v_xor_b32 v183, 224, v186
    v_cvt_pk_bf16_f32 v26, v36, v37
    v_mfma_f32_16x16x32_bf16 v[56:59], v[100:103], v[172:175], v[56:59]
    v_cvt_pk_bf16_f32 v27, v38, v39
    v_cvt_pk_bf16_f32 v28, v28, v29
    s_waitcnt lgkmcnt(8)
    v_mfma_f32_16x16x32_bf16 v[60:63], v[108:111], v[156:159], v[60:63]
    v_cvt_pk_bf16_f32 v29, v30, v31
    v_cvt_pk_bf16_f32 v30, v40, v41
    v_mfma_f32_16x16x32_bf16 v[60:63], v[104:107], v[152:155], v[60:63]
    v_cvt_pk_bf16_f32 v31, v42, v43
    v_cvt_pk_bf16_f32 v32, v32, v33
    v_mfma_f32_16x16x32_bf16 v[64:67], v[104:107], v[160:163], v[64:67]
    v_cvt_pk_bf16_f32 v33, v34, v35
    v_cvt_pk_bf16_f32 v34, v44, v45
    v_mfma_f32_16x16x32_bf16 v[64:67], v[108:111], v[164:167], v[64:67]
    v_cvt_pk_bf16_f32 v35, v46, v47
    s_waitcnt lgkmcnt(0)
    s_barrier
    v_mfma_f32_16x16x32_bf16 v[68:71], v[108:111], v[172:175], v[68:71]
    ds_read_b64 v[192:193], v176 offset:8192
    ds_read_b64 v[194:195], v177 offset:8192
    v_mfma_f32_16x16x32_bf16 v[68:71], v[104:107], v[168:171], v[68:71]
    ds_read_b64 v[196:197], v178 offset:8192
    ds_read_b64 v[198:199], v179 offset:8192
    v_mfma_f32_16x16x32_bf16 v[72:75], v[112:115], v[152:155], v[72:75]
    ds_read_b64 v[200:201], v180 offset:8192
    ds_read_b64 v[202:203], v181 offset:8192
    v_mfma_f32_16x16x32_bf16 v[72:75], v[116:119], v[156:159], v[72:75]
    ds_read_b64 v[204:205], v182 offset:8192
    ds_read_b64 v[206:207], v183 offset:8192
    v_mfma_f32_16x16x32_bf16 v[76:79], v[116:119], v[164:167], v[76:79]
    ds_read_b64 v[208:209], v176 offset:16384
    ds_read_b64 v[210:211], v177 offset:16384
    v_mfma_f32_16x16x32_bf16 v[76:79], v[112:115], v[160:163], v[76:79]
    ds_read_b64 v[212:213], v178 offset:16384
    ds_read_b64 v[214:215], v179 offset:16384
    v_mfma_f32_16x16x32_bf16 v[80:83], v[112:115], v[168:171], v[80:83]
    v_cvt_pk_bf16_f32 v48, v48, v49
    v_cvt_pk_bf16_f32 v49, v50, v51
    v_mfma_f32_16x16x32_bf16 v[80:83], v[116:119], v[172:175], v[80:83]
    v_cvt_pk_bf16_f32 v50, v60, v61
    v_mfma_f32_16x16x32_bf16 v[84:87], v[124:127], v[156:159], v[84:87]
    v_cvt_pk_bf16_f32 v51, v62, v63
    v_cvt_pk_bf16_f32 v52, v52, v53
    v_mfma_f32_16x16x32_bf16 v[84:87], v[120:123], v[152:155], v[84:87]
    v_cvt_pk_bf16_f32 v53, v54, v55
    v_mfma_f32_16x16x32_bf16 v[88:91], v[120:123], v[160:163], v[88:91]
    v_cvt_pk_bf16_f32 v54, v64, v65
    v_cvt_pk_bf16_f32 v55, v66, v67
    v_mfma_f32_16x16x32_bf16 v[88:91], v[124:127], v[164:167], v[88:91]
    v_cvt_pk_bf16_f32 v56, v56, v57
    v_mfma_f32_16x16x32_bf16 v[92:95], v[124:127], v[172:175], v[92:95]
    v_cvt_pk_bf16_f32 v57, v58, v59
    v_cvt_pk_bf16_f32 v58, v68, v69
    v_mfma_f32_16x16x32_bf16 v[92:95], v[120:123], v[168:171], v[92:95]
    v_cvt_pk_bf16_f32 v59, v70, v71
    s_waitcnt lgkmcnt(4)
    v_mfma_f32_16x16x32_bf16 v[12:15], v[192:195], v[0:3], 0
    ds_read_b64 v[216:217], v180 offset:16384
    ds_read_b64 v[218:219], v181 offset:16384
    v_mfma_f32_16x16x32_bf16 v[12:15], v[196:199], v[24:27], v[12:15]
    ds_read_b64 v[220:221], v182 offset:16384
    ds_read_b64 v[222:223], v183 offset:16384
    v_mfma_f32_16x16x32_bf16 v[12:15], v[200:203], v[48:51], v[12:15]
    v_cvt_pk_bf16_f32 v72, v72, v73
    v_cvt_pk_bf16_f32 v73, v74, v75
    v_mfma_f32_16x16x32_bf16 v[16:19], v[192:195], v[4:7], 0
    v_cvt_pk_bf16_f32 v74, v84, v85
    v_cvt_pk_bf16_f32 v75, v86, v87
    v_mfma_f32_16x16x32_bf16 v[16:19], v[196:199], v[28:31], v[16:19]
    v_cvt_pk_bf16_f32 v76, v76, v77
    v_cvt_pk_bf16_f32 v77, v78, v79
    v_mfma_f32_16x16x32_bf16 v[16:19], v[200:203], v[52:55], v[16:19]
    v_cvt_pk_bf16_f32 v78, v88, v89
    v_cvt_pk_bf16_f32 v79, v90, v91
    v_mfma_f32_16x16x32_bf16 v[20:23], v[192:195], v[8:11], 0
    v_cvt_pk_bf16_f32 v80, v80, v81
    v_cvt_pk_bf16_f32 v81, v82, v83
    v_mfma_f32_16x16x32_bf16 v[20:23], v[196:199], v[32:35], v[20:23]
    v_cvt_pk_bf16_f32 v82, v92, v93
    v_cvt_pk_bf16_f32 v83, v94, v95
    v_mfma_f32_16x16x32_bf16 v[20:23], v[200:203], v[56:59], v[20:23]
    ds_read_b64 v[96:97], v176 offset:24576
    ds_read_b64 v[98:99], v177 offset:24576
    v_mfma_f32_16x16x32_bf16 v[12:15], v[204:207], v[72:75], v[12:15]
    ds_read_b64 v[100:101], v178 offset:24576
    ds_read_b64 v[102:103], v179 offset:24576
    v_mfma_f32_16x16x32_bf16 v[16:19], v[204:207], v[76:79], v[16:19]
    ds_read_b64 v[104:105], v180 offset:24576
    ds_read_b64 v[106:107], v181 offset:24576
    v_mfma_f32_16x16x32_bf16 v[20:23], v[204:207], v[80:83], v[20:23]
    ds_read_b64 v[108:109], v182 offset:24576
    ds_read_b64 v[110:111], v183 offset:24576
    s_waitcnt lgkmcnt(8)
    v_mfma_f32_16x16x32_bf16 v[36:39], v[208:211], v[0:3], 0
    ds_read_b64 v[192:193], v176 offset:32768
    v_mfma_f32_16x16x32_bf16 v[36:39], v[212:215], v[24:27], v[36:39]
    ds_read_b64 v[194:195], v177 offset:32768
    v_mfma_f32_16x16x32_bf16 v[36:39], v[216:219], v[48:51], v[36:39]
    ds_read_b64 v[196:197], v178 offset:32768
    v_mfma_f32_16x16x32_bf16 v[36:39], v[220:223], v[72:75], v[36:39]
    ds_read_b64 v[198:199], v179 offset:32768
    v_mfma_f32_16x16x32_bf16 v[40:43], v[208:211], v[4:7], 0
    ds_read_b64 v[200:201], v180 offset:32768
    v_mfma_f32_16x16x32_bf16 v[40:43], v[212:215], v[28:31], v[40:43]
    ds_read_b64 v[202:203], v181 offset:32768
    v_max3_f32 v224, v12, v13, v14
    v_mfma_f32_16x16x32_bf16 v[40:43], v[216:219], v[52:55], v[40:43]
    ds_read_b64 v[204:205], v182 offset:32768
    v_max_f32 v224, v224, v15
    v_mfma_f32_16x16x32_bf16 v[40:43], v[220:223], v[76:79], v[40:43]
    ds_read_b64 v[206:207], v183 offset:32768
    v_max3_f32 v225, v16, v17, v18
    v_mfma_f32_16x16x32_bf16 v[44:47], v[208:211], v[8:11], 0
    v_max_f32 v225, v225, v19
    v_mfma_f32_16x16x32_bf16 v[44:47], v[212:215], v[32:35], v[44:47]
    v_max3_f32 v226, v20, v21, v22
    v_mfma_f32_16x16x32_bf16 v[44:47], v[216:219], v[56:59], v[44:47]
    v_max_f32 v226, v226, v23
    v_mfma_f32_16x16x32_bf16 v[44:47], v[220:223], v[80:83], v[44:47]
    s_waitcnt lgkmcnt(8)
    v_mfma_f32_16x16x32_bf16 v[60:63], v[96:99], v[0:3], 0
    ds_read_b64 v[208:209], v176 offset:40960
    v_mfma_f32_16x16x32_bf16 v[60:63], v[100:103], v[24:27], v[60:63]
    ds_read_b64 v[210:211], v177 offset:40960
    v_mfma_f32_16x16x32_bf16 v[60:63], v[104:107], v[48:51], v[60:63]
    ds_read_b64 v[212:213], v178 offset:40960
    v_mfma_f32_16x16x32_bf16 v[60:63], v[108:111], v[72:75], v[60:63]
    ds_read_b64 v[214:215], v179 offset:40960
    v_mfma_f32_16x16x32_bf16 v[64:67], v[96:99], v[4:7], 0
    ds_read_b64 v[216:217], v180 offset:40960
    v_mfma_f32_16x16x32_bf16 v[64:67], v[100:103], v[28:31], v[64:67]
    ds_read_b64 v[218:219], v181 offset:40960
    v_mfma_f32_16x16x32_bf16 v[64:67], v[104:107], v[52:55], v[64:67]
    ds_read_b64 v[220:221], v182 offset:40960
    v_max3_f32 v224, v224, v36, v37
    v_mfma_f32_16x16x32_bf16 v[64:67], v[108:111], v[76:79], v[64:67]
    ds_read_b64 v[222:223], v183 offset:40960
    v_max3_f32 v224, v224, v38, v39
    v_mfma_f32_16x16x32_bf16 v[68:71], v[96:99], v[8:11], 0
    v_max3_f32 v225, v225, v40, v41
    v_mfma_f32_16x16x32_bf16 v[68:71], v[100:103], v[32:35], v[68:71]
    v_max3_f32 v225, v225, v42, v43
    v_mfma_f32_16x16x32_bf16 v[68:71], v[104:107], v[56:59], v[68:71]
    v_max3_f32 v226, v226, v44, v45
    v_mfma_f32_16x16x32_bf16 v[68:71], v[108:111], v[80:83], v[68:71]
    v_max3_f32 v226, v226, v46, v47
    s_waitcnt lgkmcnt(8)
    v_mfma_f32_16x16x32_bf16 v[128:131], v[192:195], v[0:3], 0
    ds_read_b64 v[96:97], v176 offset:0
    v_mfma_f32_16x16x32_bf16 v[128:131], v[196:199], v[24:27], v[128:131]
    ds_read_b64 v[98:99], v177 offset:0
    v_mfma_f32_16x16x32_bf16 v[128:131], v[200:203], v[48:51], v[128:131]
    ds_read_b64 v[100:101], v178 offset:0
    v_mfma_f32_16x16x32_bf16 v[128:131], v[204:207], v[72:75], v[128:131]
    ds_read_b64 v[102:103], v179 offset:0
    v_mfma_f32_16x16x32_bf16 v[132:135], v[192:195], v[4:7], 0
    ds_read_b64 v[104:105], v180 offset:0
    v_mfma_f32_16x16x32_bf16 v[132:135], v[196:199], v[28:31], v[132:135]
    ds_read_b64 v[106:107], v181 offset:0
    v_mfma_f32_16x16x32_bf16 v[132:135], v[200:203], v[52:55], v[132:135]
    ds_read_b64 v[108:109], v182 offset:0
    v_max3_f32 v224, v224, v60, v61
    v_mfma_f32_16x16x32_bf16 v[132:135], v[204:207], v[76:79], v[132:135]
    ds_read_b64 v[110:111], v183 offset:0
    v_max3_f32 v224, v224, v62, v63
    v_mfma_f32_16x16x32_bf16 v[136:139], v[192:195], v[8:11], 0
    v_max3_f32 v225, v225, v64, v65
    v_mfma_f32_16x16x32_bf16 v[136:139], v[196:199], v[32:35], v[136:139]
    v_max3_f32 v225, v225, v66, v67
    v_mfma_f32_16x16x32_bf16 v[136:139], v[200:203], v[56:59], v[136:139]
    v_max3_f32 v226, v226, v68, v69
    v_mfma_f32_16x16x32_bf16 v[136:139], v[204:207], v[80:83], v[136:139]
    v_max3_f32 v226, v226, v70, v71
    s_waitcnt lgkmcnt(8)
    v_mfma_f32_16x16x32_bf16 v[140:143], v[208:211], v[0:3], 0
    v_xor_b32 v176, 0, v191
    v_xor_b32 v177, 32, v191
    v_mfma_f32_16x16x32_bf16 v[140:143], v[212:215], v[24:27], v[140:143]
    v_xor_b32 v178, 64, v191
    v_xor_b32 v179, 96, v191
    v_mfma_f32_16x16x32_bf16 v[140:143], v[216:219], v[48:51], v[140:143]
    v_xor_b32 v180, 128, v191
    v_xor_b32 v181, 160, v191
    v_mfma_f32_16x16x32_bf16 v[140:143], v[220:223], v[72:75], v[140:143]
    v_mfma_f32_16x16x32_bf16 v[144:147], v[208:211], v[4:7], 0
    v_max3_f32 v224, v224, v128, v129
    v_mfma_f32_16x16x32_bf16 v[144:147], v[212:215], v[28:31], v[144:147]
    v_max3_f32 v224, v224, v130, v131
    v_mfma_f32_16x16x32_bf16 v[144:147], v[216:219], v[52:55], v[144:147]
    v_max3_f32 v225, v225, v132, v133
    v_mfma_f32_16x16x32_bf16 v[144:147], v[220:223], v[76:79], v[144:147]
    v_max3_f32 v225, v225, v134, v135
    v_mfma_f32_16x16x32_bf16 v[148:151], v[208:211], v[8:11], 0
    v_max3_f32 v226, v226, v136, v137
    v_mfma_f32_16x16x32_bf16 v[148:151], v[212:215], v[32:35], v[148:151]
    v_max3_f32 v226, v226, v138, v139
    v_mfma_f32_16x16x32_bf16 v[148:151], v[216:219], v[56:59], v[148:151]
    v_xor_b32 v182, 192, v191
    v_xor_b32 v183, 224, v191
    v_mfma_f32_16x16x32_bf16 v[148:151], v[220:223], v[80:83], v[148:151]
    s_waitcnt lgkmcnt(0)
    v_mfma_f32_16x16x32_bf16 v[84:87], v[96:99], v[0:3], 0
    s_mov_b32 s30, 0x3e0293ee
    s_mov_b32 s31, 0x3e0293ee
    v_mfma_f32_16x16x32_bf16 v[84:87], v[100:103], v[24:27], v[84:87]
    v_mov_b32 v236, 0x3f803f80
    v_mov_b32 v237, 0x3f803f80
    v_mfma_f32_16x16x32_bf16 v[84:87], v[104:107], v[48:51], v[84:87]
    v_mov_b32 v238, 0x3f803f80
    v_mov_b32 v239, 0x3f803f80
    v_mfma_f32_16x16x32_bf16 v[84:87], v[108:111], v[72:75], v[84:87]
    v_mfma_f32_16x16x32_bf16 v[88:91], v[96:99], v[4:7], 0
    v_max3_f32 v224, v224, v140, v141
    v_mfma_f32_16x16x32_bf16 v[88:91], v[100:103], v[28:31], v[88:91]
    v_max3_f32 v224, v224, v142, v143
    v_mfma_f32_16x16x32_bf16 v[88:91], v[104:107], v[52:55], v[88:91]
    v_max3_f32 v225, v225, v144, v145
    v_mfma_f32_16x16x32_bf16 v[88:91], v[108:111], v[76:79], v[88:91]
    v_max3_f32 v225, v225, v146, v147
    v_mfma_f32_16x16x32_bf16 v[92:95], v[96:99], v[8:11], 0
    v_max3_f32 v226, v226, v148, v149
    v_mfma_f32_16x16x32_bf16 v[92:95], v[100:103], v[32:35], v[92:95]
    v_max3_f32 v226, v226, v150, v151
    v_mfma_f32_16x16x32_bf16 v[92:95], v[104:107], v[56:59], v[92:95]
    v_max3_f32 v224, v224, v84, v85
    v_mfma_f32_16x16x32_bf16 v[92:95], v[108:111], v[80:83], v[92:95]
    v_max3_f32 v224, v224, v86, v87
    v_mov_b32 v228, v224
    v_max3_f32 v225, v225, v88, v89
    v_max3_f32 v225, v225, v90, v91
    v_permlane32_swap_b32 v224, v228
    v_mov_b32 v229, v225
    v_max_f32 v224, v224, v228
    v_mov_b32 v228, v224
    v_permlane32_swap_b32 v225, v229
    v_max3_f32 v226, v226, v92, v93
    v_max3_f32 v226, v226, v94, v95
    v_permlane16_swap_b32 v224, v228
    v_mov_b32 v230, v226
    v_max_f32 v225, v225, v229
    v_mov_b32 v229, v225
    v_permlane32_swap_b32 v226, v230
    v_max_f32 v224, v224, v228
    v_permlane16_swap_b32 v225, v229
    v_max_f32 v226, v226, v230
    v_mov_b32 v230, v226
    v_max_f32 v225, v225, v229
    s_nop 0
    v_permlane16_swap_b32 v226, v230
    v_max_f32 v226, v226, v230
    v_mul_f32 v228, s30, v224
    v_mul_f32 v230, s30, v225
    v_mul_f32 v232, s30, v226
    v_pk_fma_f32 v[12:13], v[12:13], s[30:31], v[228:229] op_sel_hi:[1,1,0] neg_lo:[0,0,1] neg_hi:[0,0,1]
    v_pk_fma_f32 v[14:15], v[14:15], s[30:31], v[228:229] op_sel_hi:[1,1,0] neg_lo:[0,0,1] neg_hi:[0,0,1]
    v_pk_fma_f32 v[36:37], v[36:37], s[30:31], v[228:229] op_sel_hi:[1,1,0] neg_lo:[0,0,1] neg_hi:[0,0,1]
    v_pk_fma_f32 v[38:39], v[38:39], s[30:31], v[228:229] op_sel_hi:[1,1,0] neg_lo:[0,0,1] neg_hi:[0,0,1]
    v_exp_f32 v12, v12
    v_exp_f32 v13, v13
    v_exp_f32 v14, v14
    v_exp_f32 v15, v15
    v_exp_f32 v36, v36
    v_exp_f32 v37, v37
    v_exp_f32 v38, v38
    v_exp_f32 v39, v39
    v_cvt_pk_bf16_f32 v152, v12, v13
    v_cvt_pk_bf16_f32 v153, v14, v15
    v_cvt_pk_bf16_f32 v154, v36, v37
    v_cvt_pk_bf16_f32 v155, v38, v39
    v_pk_fma_f32 v[16:17], v[16:17], s[30:31], v[230:231] op_sel_hi:[1,1,0] neg_lo:[0,0,1] neg_hi:[0,0,1]
    v_pk_fma_f32 v[18:19], v[18:19], s[30:31], v[230:231] op_sel_hi:[1,1,0] neg_lo:[0,0,1] neg_hi:[0,0,1]
    v_pk_fma_f32 v[40:41], v[40:41], s[30:31], v[230:231] op_sel_hi:[1,1,0] neg_lo:[0,0,1] neg_hi:[0,0,1]
    v_pk_fma_f32 v[42:43], v[42:43], s[30:31], v[230:231] op_sel_hi:[1,1,0] neg_lo:[0,0,1] neg_hi:[0,0,1]
    v_mfma_f32_16x16x32_bf16 v[240:243], v[236:239], v[152:155], 0
    v_exp_f32 v16, v16
    v_exp_f32 v17, v17
    v_exp_f32 v18, v18
    v_exp_f32 v19, v19
    v_exp_f32 v40, v40
    v_exp_f32 v41, v41
    v_exp_f32 v42, v42
    v_exp_f32 v43, v43
    v_cvt_pk_bf16_f32 v156, v16, v17
    v_cvt_pk_bf16_f32 v157, v18, v19
    v_cvt_pk_bf16_f32 v158, v40, v41
    v_cvt_pk_bf16_f32 v159, v42, v43
    v_pk_fma_f32 v[20:21], v[20:21], s[30:31], v[232:233] op_sel_hi:[1,1,0] neg_lo:[0,0,1] neg_hi:[0,0,1]
    v_pk_fma_f32 v[22:23], v[22:23], s[30:31], v[232:233] op_sel_hi:[1,1,0] neg_lo:[0,0,1] neg_hi:[0,0,1]
    v_pk_fma_f32 v[44:45], v[44:45], s[30:31], v[232:233] op_sel_hi:[1,1,0] neg_lo:[0,0,1] neg_hi:[0,0,1]
    v_pk_fma_f32 v[46:47], v[46:47], s[30:31], v[232:233] op_sel_hi:[1,1,0] neg_lo:[0,0,1] neg_hi:[0,0,1]
    v_mfma_f32_16x16x32_bf16 v[244:247], v[236:239], v[156:159], 0
    v_exp_f32 v20, v20
    v_exp_f32 v21, v21
    v_exp_f32 v22, v22
    v_exp_f32 v23, v23
    v_exp_f32 v44, v44
    v_exp_f32 v45, v45
    v_exp_f32 v46, v46
    v_exp_f32 v47, v47
    v_cvt_pk_bf16_f32 v160, v20, v21
    v_cvt_pk_bf16_f32 v161, v22, v23
    v_cvt_pk_bf16_f32 v162, v44, v45
    v_cvt_pk_bf16_f32 v163, v46, v47
    v_pk_fma_f32 v[60:61], v[60:61], s[30:31], v[228:229] op_sel_hi:[1,1,0] neg_lo:[0,0,1] neg_hi:[0,0,1]
    v_pk_fma_f32 v[62:63], v[62:63], s[30:31], v[228:229] op_sel_hi:[1,1,0] neg_lo:[0,0,1] neg_hi:[0,0,1]
    v_pk_fma_f32 v[128:129], v[128:129], s[30:31], v[228:229] op_sel_hi:[1,1,0] neg_lo:[0,0,1] neg_hi:[0,0,1]
    v_pk_fma_f32 v[130:131], v[130:131], s[30:31], v[228:229] op_sel_hi:[1,1,0] neg_lo:[0,0,1] neg_hi:[0,0,1]
    v_mfma_f32_16x16x32_bf16 v[248:251], v[236:239], v[160:163], 0
    v_exp_f32 v60, v60
    v_exp_f32 v61, v61
    v_exp_f32 v62, v62
    v_exp_f32 v63, v63
    v_exp_f32 v128, v128
    v_exp_f32 v129, v129
    v_exp_f32 v130, v130
    v_exp_f32 v131, v131
    v_cvt_pk_bf16_f32 v164, v60, v61
    v_cvt_pk_bf16_f32 v165, v62, v63
    v_cvt_pk_bf16_f32 v166, v128, v129
    v_cvt_pk_bf16_f32 v167, v130, v131
    v_pk_fma_f32 v[64:65], v[64:65], s[30:31], v[230:231] op_sel_hi:[1,1,0] neg_lo:[0,0,1] neg_hi:[0,0,1]
    v_pk_fma_f32 v[66:67], v[66:67], s[30:31], v[230:231] op_sel_hi:[1,1,0] neg_lo:[0,0,1] neg_hi:[0,0,1]
    v_pk_fma_f32 v[132:133], v[132:133], s[30:31], v[230:231] op_sel_hi:[1,1,0] neg_lo:[0,0,1] neg_hi:[0,0,1]
    v_pk_fma_f32 v[134:135], v[134:135], s[30:31], v[230:231] op_sel_hi:[1,1,0] neg_lo:[0,0,1] neg_hi:[0,0,1]
    v_mfma_f32_16x16x32_bf16 v[240:243], v[236:239], v[164:167], v[240:243]
    v_exp_f32 v64, v64
    v_exp_f32 v65, v65
    v_exp_f32 v66, v66
    v_exp_f32 v67, v67
    v_exp_f32 v132, v132
    v_exp_f32 v133, v133
    v_exp_f32 v134, v134
    v_exp_f32 v135, v135
    v_cvt_pk_bf16_f32 v168, v64, v65
    v_cvt_pk_bf16_f32 v169, v66, v67
    v_cvt_pk_bf16_f32 v170, v132, v133
    v_cvt_pk_bf16_f32 v171, v134, v135
    v_pk_fma_f32 v[68:69], v[68:69], s[30:31], v[232:233] op_sel_hi:[1,1,0] neg_lo:[0,0,1] neg_hi:[0,0,1]
    v_pk_fma_f32 v[70:71], v[70:71], s[30:31], v[232:233] op_sel_hi:[1,1,0] neg_lo:[0,0,1] neg_hi:[0,0,1]
    v_pk_fma_f32 v[136:137], v[136:137], s[30:31], v[232:233] op_sel_hi:[1,1,0] neg_lo:[0,0,1] neg_hi:[0,0,1]
    v_pk_fma_f32 v[138:139], v[138:139], s[30:31], v[232:233] op_sel_hi:[1,1,0] neg_lo:[0,0,1] neg_hi:[0,0,1]
    v_mfma_f32_16x16x32_bf16 v[244:247], v[236:239], v[168:171], v[244:247]
    v_exp_f32 v68, v68
    v_exp_f32 v69, v69
    v_exp_f32 v70, v70
    v_exp_f32 v71, v71
    v_exp_f32 v136, v136
    v_exp_f32 v137, v137
    v_exp_f32 v138, v138
    v_exp_f32 v139, v139
    v_cvt_pk_bf16_f32 v172, v68, v69
    v_cvt_pk_bf16_f32 v173, v70, v71
    v_cvt_pk_bf16_f32 v174, v136, v137
    v_cvt_pk_bf16_f32 v175, v138, v139
    v_pk_fma_f32 v[140:141], v[140:141], s[30:31], v[228:229] op_sel_hi:[1,1,0] neg_lo:[0,0,1] neg_hi:[0,0,1]
    v_pk_fma_f32 v[142:143], v[142:143], s[30:31], v[228:229] op_sel_hi:[1,1,0] neg_lo:[0,0,1] neg_hi:[0,0,1]
    v_pk_fma_f32 v[84:85], v[84:85], s[30:31], v[228:229] op_sel_hi:[1,1,0] neg_lo:[0,0,1] neg_hi:[0,0,1]
    v_pk_fma_f32 v[86:87], v[86:87], s[30:31], v[228:229] op_sel_hi:[1,1,0] neg_lo:[0,0,1] neg_hi:[0,0,1]
    v_mfma_f32_16x16x32_bf16 v[248:251], v[236:239], v[172:175], v[248:251]
    v_exp_f32 v140, v140
    v_exp_f32 v141, v141
    v_exp_f32 v142, v142
    v_exp_f32 v143, v143
    v_exp_f32 v84, v84
    v_exp_f32 v85, v85
    v_exp_f32 v86, v86
    v_exp_f32 v87, v87
    v_cvt_pk_bf16_f32 v96, v140, v141
    v_cvt_pk_bf16_f32 v97, v142, v143
    v_cvt_pk_bf16_f32 v98, v84, v85
    v_cvt_pk_bf16_f32 v99, v86, v87
    v_pk_fma_f32 v[144:145], v[144:145], s[30:31], v[230:231] op_sel_hi:[1,1,0] neg_lo:[0,0,1] neg_hi:[0,0,1]
    v_pk_fma_f32 v[146:147], v[146:147], s[30:31], v[230:231] op_sel_hi:[1,1,0] neg_lo:[0,0,1] neg_hi:[0,0,1]
    v_pk_fma_f32 v[88:89], v[88:89], s[30:31], v[230:231] op_sel_hi:[1,1,0] neg_lo:[0,0,1] neg_hi:[0,0,1]
    v_pk_fma_f32 v[90:91], v[90:91], s[30:31], v[230:231] op_sel_hi:[1,1,0] neg_lo:[0,0,1] neg_hi:[0,0,1]
    v_mfma_f32_16x16x32_bf16 v[240:243], v[236:239], v[96:99], v[240:243]
    v_exp_f32 v144, v144
    v_exp_f32 v145, v145
    v_exp_f32 v146, v146
    v_exp_f32 v147, v147
    v_exp_f32 v88, v88
    v_exp_f32 v89, v89
    v_exp_f32 v90, v90
    v_exp_f32 v91, v91
    v_cvt_pk_bf16_f32 v100, v144, v145
    v_cvt_pk_bf16_f32 v101, v146, v147
    v_cvt_pk_bf16_f32 v102, v88, v89
    v_cvt_pk_bf16_f32 v103, v90, v91
    v_pk_fma_f32 v[148:149], v[148:149], s[30:31], v[232:233] op_sel_hi:[1,1,0] neg_lo:[0,0,1] neg_hi:[0,0,1]
    v_pk_fma_f32 v[150:151], v[150:151], s[30:31], v[232:233] op_sel_hi:[1,1,0] neg_lo:[0,0,1] neg_hi:[0,0,1]
    v_pk_fma_f32 v[92:93], v[92:93], s[30:31], v[232:233] op_sel_hi:[1,1,0] neg_lo:[0,0,1] neg_hi:[0,0,1]
    v_pk_fma_f32 v[94:95], v[94:95], s[30:31], v[232:233] op_sel_hi:[1,1,0] neg_lo:[0,0,1] neg_hi:[0,0,1]
    v_mfma_f32_16x16x32_bf16 v[244:247], v[236:239], v[100:103], v[244:247]
    v_exp_f32 v148, v148
    v_exp_f32 v149, v149
    v_exp_f32 v150, v150
    v_exp_f32 v151, v151
    v_exp_f32 v92, v92
    v_exp_f32 v93, v93
    v_exp_f32 v94, v94
    v_exp_f32 v95, v95
    v_cvt_pk_bf16_f32 v104, v148, v149
    v_cvt_pk_bf16_f32 v105, v150, v151
    v_cvt_pk_bf16_f32 v106, v92, v93
    v_cvt_pk_bf16_f32 v107, v94, v95
    s_barrier
    ds_read_b64_tr_b16 v[192:193], v176 offset:0
    ds_read_b64_tr_b16 v[194:195], v176 offset:4096
    ds_read_b64_tr_b16 v[196:197], v176 offset:8192
    ds_read_b64_tr_b16 v[198:199], v176 offset:12288
    ds_read_b64_tr_b16 v[200:201], v176 offset:16384
    ds_read_b64_tr_b16 v[202:203], v176 offset:20480
    ds_read_b64_tr_b16 v[204:205], v177 offset:0
    ds_read_b64_tr_b16 v[206:207], v177 offset:4096
    ds_read_b64_tr_b16 v[208:209], v177 offset:8192
    ds_read_b64_tr_b16 v[210:211], v177 offset:12288
    ds_read_b64_tr_b16 v[212:213], v177 offset:16384
    ds_read_b64_tr_b16 v[214:215], v177 offset:20480
    v_mfma_f32_16x16x32_bf16 v[248:251], v[236:239], v[104:107], v[248:251]
    s_waitcnt lgkmcnt(6)
    v_mfma_f32_16x16x32_bf16 v[0:3], v[192:195], v[152:155], 0
    ds_read_b64_tr_b16 v[108:109], v178 offset:0
    v_mfma_f32_16x16x32_bf16 v[0:3], v[196:199], v[164:167], v[0:3]
    ds_read_b64_tr_b16 v[110:111], v178 offset:4096
    v_mfma_f32_16x16x32_bf16 v[0:3], v[200:203], v[96:99], v[0:3]
    ds_read_b64_tr_b16 v[112:113], v178 offset:8192
    v_mfma_f32_16x16x32_bf16 v[4:7], v[192:195], v[156:159], 0
    ds_read_b64_tr_b16 v[114:115], v178 offset:12288
    v_mfma_f32_16x16x32_bf16 v[4:7], v[196:199], v[168:171], v[4:7]
    ds_read_b64_tr_b16 v[116:117], v178 offset:16384
    v_mfma_f32_16x16x32_bf16 v[4:7], v[200:203], v[100:103], v[4:7]
    ds_read_b64_tr_b16 v[118:119], v178 offset:20480
    v_mfma_f32_16x16x32_bf16 v[8:11], v[192:195], v[160:163], 0
    v_mfma_f32_16x16x32_bf16 v[8:11], v[196:199], v[172:175], v[8:11]
    v_mfma_f32_16x16x32_bf16 v[8:11], v[200:203], v[104:107], v[8:11]
    s_waitcnt lgkmcnt(6)
    v_mfma_f32_16x16x32_bf16 v[12:15], v[204:207], v[152:155], 0
    ds_read_b64_tr_b16 v[192:193], v179 offset:0
    v_rcp_f32 v228, v240
    v_mfma_f32_16x16x32_bf16 v[12:15], v[208:211], v[164:167], v[12:15]
    ds_read_b64_tr_b16 v[194:195], v179 offset:4096
    v_rcp_f32 v230, v244
    v_mfma_f32_16x16x32_bf16 v[12:15], v[212:215], v[96:99], v[12:15]
    ds_read_b64_tr_b16 v[196:197], v179 offset:8192
    v_rcp_f32 v232, v248
    v_mfma_f32_16x16x32_bf16 v[16:19], v[204:207], v[156:159], 0
    ds_read_b64_tr_b16 v[198:199], v179 offset:12288
    v_mfma_f32_16x16x32_bf16 v[16:19], v[208:211], v[168:171], v[16:19]
    ds_read_b64_tr_b16 v[200:201], v179 offset:16384
    v_mfma_f32_16x16x32_bf16 v[16:19], v[212:215], v[100:103], v[16:19]
    ds_read_b64_tr_b16 v[202:203], v179 offset:20480
    v_mfma_f32_16x16x32_bf16 v[20:23], v[204:207], v[160:163], 0
    v_mfma_f32_16x16x32_bf16 v[20:23], v[208:211], v[172:175], v[20:23]
    v_mfma_f32_16x16x32_bf16 v[20:23], v[212:215], v[104:107], v[20:23]
    s_waitcnt lgkmcnt(6)
    v_mfma_f32_16x16x32_bf16 v[24:27], v[108:111], v[152:155], 0
    ds_read_b64_tr_b16 v[204:205], v180 offset:0
    v_mfma_f32_16x16x32_bf16 v[24:27], v[112:115], v[164:167], v[24:27]
    ds_read_b64_tr_b16 v[206:207], v180 offset:4096
    v_mul_f32 v0, v0, v228
    v_mfma_f32_16x16x32_bf16 v[24:27], v[116:119], v[96:99], v[24:27]
    ds_read_b64_tr_b16 v[208:209], v180 offset:8192
    v_mul_f32 v1, v1, v228
    v_mfma_f32_16x16x32_bf16 v[28:31], v[108:111], v[156:159], 0
    ds_read_b64_tr_b16 v[210:211], v180 offset:12288
    v_mul_f32 v2, v2, v228
    v_mfma_f32_16x16x32_bf16 v[28:31], v[112:115], v[168:171], v[28:31]
    ds_read_b64_tr_b16 v[212:213], v180 offset:16384
    v_mul_f32 v3, v3, v228
    v_mfma_f32_16x16x32_bf16 v[28:31], v[116:119], v[100:103], v[28:31]
    ds_read_b64_tr_b16 v[214:215], v180 offset:20480
    v_mul_f32 v12, v12, v228
    v_mfma_f32_16x16x32_bf16 v[32:35], v[108:111], v[160:163], 0
    v_mul_f32 v13, v13, v228
    v_mul_f32 v14, v14, v228
    v_mfma_f32_16x16x32_bf16 v[32:35], v[112:115], v[172:175], v[32:35]
    v_mul_f32 v15, v15, v228
    v_cvt_pk_bf16_f32 v0, v0, v1
    v_mfma_f32_16x16x32_bf16 v[32:35], v[116:119], v[104:107], v[32:35]
    v_cvt_pk_bf16_f32 v1, v2, v3
    v_cvt_pk_bf16_f32 v2, v12, v13
    s_waitcnt lgkmcnt(6)
    v_mfma_f32_16x16x32_bf16 v[36:39], v[192:195], v[152:155], 0
    ds_read_b64_tr_b16 v[108:109], v181 offset:0
    v_cvt_pk_bf16_f32 v3, v14, v15
    v_mfma_f32_16x16x32_bf16 v[36:39], v[196:199], v[164:167], v[36:39]
    ds_read_b64_tr_b16 v[110:111], v181 offset:4096
    buffer_store_dwordx4 v[0:3], v190, s[32:35], s40 offen sc1
    v_mfma_f32_16x16x32_bf16 v[36:39], v[200:203], v[96:99], v[36:39]
    ds_read_b64_tr_b16 v[112:113], v181 offset:8192
    v_mul_f32 v4, v4, v230
    v_mfma_f32_16x16x32_bf16 v[40:43], v[192:195], v[156:159], 0
    ds_read_b64_tr_b16 v[114:115], v181 offset:12288
    v_mul_f32 v5, v5, v230
    v_mfma_f32_16x16x32_bf16 v[40:43], v[196:199], v[168:171], v[40:43]
    ds_read_b64_tr_b16 v[116:117], v181 offset:16384
    v_mul_f32 v6, v6, v230
    v_mfma_f32_16x16x32_bf16 v[40:43], v[200:203], v[100:103], v[40:43]
    ds_read_b64_tr_b16 v[118:119], v181 offset:20480
    v_mul_f32 v7, v7, v230
    v_mfma_f32_16x16x32_bf16 v[44:47], v[192:195], v[160:163], 0
    v_mul_f32 v16, v16, v230
    v_mul_f32 v17, v17, v230
    v_mfma_f32_16x16x32_bf16 v[44:47], v[196:199], v[172:175], v[44:47]
    v_mul_f32 v18, v18, v230
    v_mul_f32 v19, v19, v230
    v_mfma_f32_16x16x32_bf16 v[44:47], v[200:203], v[104:107], v[44:47]
    v_cvt_pk_bf16_f32 v4, v4, v5
    v_cvt_pk_bf16_f32 v5, v6, v7
    s_waitcnt lgkmcnt(6)
    v_mfma_f32_16x16x32_bf16 v[48:51], v[204:207], v[152:155], 0
    ds_read_b64_tr_b16 v[192:193], v182 offset:0
    v_cvt_pk_bf16_f32 v6, v16, v17
    v_mfma_f32_16x16x32_bf16 v[48:51], v[208:211], v[164:167], v[48:51]
    ds_read_b64_tr_b16 v[194:195], v182 offset:4096
    v_cvt_pk_bf16_f32 v7, v18, v19
    v_mfma_f32_16x16x32_bf16 v[48:51], v[212:215], v[96:99], v[48:51]
    ds_read_b64_tr_b16 v[196:197], v182 offset:8192
    buffer_store_dwordx4 v[4:7], v190, s[32:35], s41 offen sc1
    v_mfma_f32_16x16x32_bf16 v[52:55], v[204:207], v[156:159], 0
    ds_read_b64_tr_b16 v[198:199], v182 offset:12288
    v_mul_f32 v8, v8, v232
    v_mfma_f32_16x16x32_bf16 v[52:55], v[208:211], v[168:171], v[52:55]
    ds_read_b64_tr_b16 v[200:201], v182 offset:16384
    v_mul_f32 v9, v9, v232
    v_mfma_f32_16x16x32_bf16 v[52:55], v[212:215], v[100:103], v[52:55]
    ds_read_b64_tr_b16 v[202:203], v182 offset:20480
    v_mul_f32 v10, v10, v232
    v_mfma_f32_16x16x32_bf16 v[56:59], v[204:207], v[160:163], 0
    v_mul_f32 v11, v11, v232
    v_mul_f32 v20, v20, v232
    v_mfma_f32_16x16x32_bf16 v[56:59], v[208:211], v[172:175], v[56:59]
    v_mul_f32 v21, v21, v232
    v_mul_f32 v22, v22, v232
    v_mfma_f32_16x16x32_bf16 v[56:59], v[212:215], v[104:107], v[56:59]
    v_mul_f32 v23, v23, v232
    v_cvt_pk_bf16_f32 v8, v8, v9
    s_waitcnt lgkmcnt(6)
    v_mfma_f32_16x16x32_bf16 v[60:63], v[108:111], v[152:155], 0
    ds_read_b64_tr_b16 v[204:205], v183 offset:0
    v_cvt_pk_bf16_f32 v9, v10, v11
    v_mfma_f32_16x16x32_bf16 v[60:63], v[112:115], v[164:167], v[60:63]
    ds_read_b64_tr_b16 v[206:207], v183 offset:4096
    v_cvt_pk_bf16_f32 v10, v20, v21
    v_mfma_f32_16x16x32_bf16 v[60:63], v[116:119], v[96:99], v[60:63]
    ds_read_b64_tr_b16 v[208:209], v183 offset:8192
    v_cvt_pk_bf16_f32 v11, v22, v23
    v_mfma_f32_16x16x32_bf16 v[64:67], v[108:111], v[156:159], 0
    ds_read_b64_tr_b16 v[210:211], v183 offset:12288
    buffer_store_dwordx4 v[8:11], v190, s[32:35], s42 offen sc1
    v_mfma_f32_16x16x32_bf16 v[64:67], v[112:115], v[168:171], v[64:67]
    ds_read_b64_tr_b16 v[212:213], v183 offset:16384
    v_add_u32 v190, 8192, v190
    v_mfma_f32_16x16x32_bf16 v[64:67], v[116:119], v[100:103], v[64:67]
    ds_read_b64_tr_b16 v[214:215], v183 offset:20480
    v_mul_f32 v24, v24, v228
    v_mfma_f32_16x16x32_bf16 v[68:71], v[108:111], v[160:163], 0
    v_mul_f32 v25, v25, v228
    v_mul_f32 v26, v26, v228
    v_mfma_f32_16x16x32_bf16 v[68:71], v[112:115], v[172:175], v[68:71]
    v_mul_f32 v27, v27, v228
    v_mul_f32 v36, v36, v228
    v_mfma_f32_16x16x32_bf16 v[68:71], v[116:119], v[104:107], v[68:71]
    v_mul_f32 v37, v37, v228
    v_mul_f32 v38, v38, v228
    s_waitcnt lgkmcnt(6)
    v_mfma_f32_16x16x32_bf16 v[72:75], v[192:195], v[152:155], 0
    v_mul_f32 v39, v39, v228
    v_cvt_pk_bf16_f32 v24, v24, v25
    v_mfma_f32_16x16x32_bf16 v[72:75], v[196:199], v[164:167], v[72:75]
    v_cvt_pk_bf16_f32 v25, v26, v27
    v_cvt_pk_bf16_f32 v26, v36, v37
    v_mfma_f32_16x16x32_bf16 v[72:75], v[200:203], v[96:99], v[72:75]
    v_cvt_pk_bf16_f32 v27, v38, v39
    buffer_store_dwordx4 v[24:27], v190, s[32:35], s40 offen sc1
    v_mfma_f32_16x16x32_bf16 v[76:79], v[192:195], v[156:159], 0
    v_mul_f32 v28, v28, v230
    v_mul_f32 v29, v29, v230
    v_mfma_f32_16x16x32_bf16 v[76:79], v[196:199], v[168:171], v[76:79]
    v_mul_f32 v30, v30, v230
    v_mul_f32 v31, v31, v230
    v_mfma_f32_16x16x32_bf16 v[76:79], v[200:203], v[100:103], v[76:79]
    v_mul_f32 v40, v40, v230
    v_mul_f32 v41, v41, v230
    v_mfma_f32_16x16x32_bf16 v[80:83], v[192:195], v[160:163], 0
    v_mul_f32 v42, v42, v230
    v_mul_f32 v43, v43, v230
    v_mfma_f32_16x16x32_bf16 v[80:83], v[196:199], v[172:175], v[80:83]
    v_cvt_pk_bf16_f32 v28, v28, v29
    v_cvt_pk_bf16_f32 v29, v30, v31
    v_mfma_f32_16x16x32_bf16 v[80:83], v[200:203], v[104:107], v[80:83]
    v_cvt_pk_bf16_f32 v30, v40, v41
    v_cvt_pk_bf16_f32 v31, v42, v43
    s_waitcnt lgkmcnt(0)
    v_mfma_f32_16x16x32_bf16 v[84:87], v[204:207], v[152:155], 0
    buffer_store_dwordx4 v[28:31], v190, s[32:35], s41 offen sc1
    v_mul_f32 v32, v32, v232
    v_mfma_f32_16x16x32_bf16 v[84:87], v[208:211], v[164:167], v[84:87]
    v_mul_f32 v33, v33, v232
    v_mul_f32 v34, v34, v232
    v_mfma_f32_16x16x32_bf16 v[84:87], v[212:215], v[96:99], v[84:87]
    v_mul_f32 v35, v35, v232
    v_mul_f32 v44, v44, v232
    v_mfma_f32_16x16x32_bf16 v[88:91], v[204:207], v[156:159], 0
    v_mul_f32 v45, v45, v232
    v_mul_f32 v46, v46, v232
    v_mfma_f32_16x16x32_bf16 v[88:91], v[208:211], v[168:171], v[88:91]
    v_mul_f32 v47, v47, v232
    v_cvt_pk_bf16_f32 v32, v32, v33
    v_mfma_f32_16x16x32_bf16 v[88:91], v[212:215], v[100:103], v[88:91]
    v_cvt_pk_bf16_f32 v33, v34, v35
    v_cvt_pk_bf16_f32 v34, v44, v45
    v_mfma_f32_16x16x32_bf16 v[92:95], v[204:207], v[160:163], 0
    v_cvt_pk_bf16_f32 v35, v46, v47
    buffer_store_dwordx4 v[32:35], v190, s[32:35], s42 offen sc1
    v_mfma_f32_16x16x32_bf16 v[92:95], v[208:211], v[172:175], v[92:95]
    v_add_u32 v190, 8192, v190
    v_mul_f32 v48, v48, v228
    v_mfma_f32_16x16x32_bf16 v[92:95], v[212:215], v[104:107], v[92:95]
    v_mul_f32 v49, v49, v228
    v_mul_f32 v50, v50, v228
    v_mul_f32 v51, v51, v228
    v_mul_f32 v60, v60, v228
    v_mul_f32 v61, v61, v228
    v_mul_f32 v62, v62, v228
    v_mul_f32 v63, v63, v228
    v_cvt_pk_bf16_f32 v48, v48, v49
    v_cvt_pk_bf16_f32 v49, v50, v51
    v_cvt_pk_bf16_f32 v50, v60, v61
    v_cvt_pk_bf16_f32 v51, v62, v63
    buffer_store_dwordx4 v[48:51], v190, s[32:35], s40 offen sc1
    v_mul_f32 v52, v52, v230
    v_mul_f32 v53, v53, v230
    v_mul_f32 v54, v54, v230
    v_mul_f32 v55, v55, v230
    v_mul_f32 v64, v64, v230
    v_mul_f32 v65, v65, v230
    v_mul_f32 v66, v66, v230
    v_mul_f32 v67, v67, v230
    v_cvt_pk_bf16_f32 v52, v52, v53
    v_cvt_pk_bf16_f32 v53, v54, v55
    v_cvt_pk_bf16_f32 v54, v64, v65
    v_cvt_pk_bf16_f32 v55, v66, v67
    buffer_store_dwordx4 v[52:55], v190, s[32:35], s41 offen sc1
    v_mul_f32 v56, v56, v232
    v_mul_f32 v57, v57, v232
    v_mul_f32 v58, v58, v232
    v_mul_f32 v59, v59, v232
    v_mul_f32 v68, v68, v232
    v_mul_f32 v69, v69, v232
    v_mul_f32 v70, v70, v232
    v_mul_f32 v71, v71, v232
    v_cvt_pk_bf16_f32 v56, v56, v57
    v_cvt_pk_bf16_f32 v57, v58, v59
    v_cvt_pk_bf16_f32 v58, v68, v69
    v_cvt_pk_bf16_f32 v59, v70, v71
    buffer_store_dwordx4 v[56:59], v190, s[32:35], s42 offen sc1
    v_add_u32 v190, 8192, v190
    v_pk_mul_f32 v[72:73], v[72:73], v[228:229] op_sel_hi:[1,0]
    v_pk_mul_f32 v[74:75], v[74:75], v[228:229] op_sel_hi:[1,0]
    v_pk_mul_f32 v[84:85], v[84:85], v[228:229] op_sel_hi:[1,0]
    v_pk_mul_f32 v[86:87], v[86:87], v[228:229] op_sel_hi:[1,0]
    v_cvt_pk_bf16_f32 v72, v72, v73
    v_cvt_pk_bf16_f32 v73, v74, v75
    v_cvt_pk_bf16_f32 v74, v84, v85
    v_cvt_pk_bf16_f32 v75, v86, v87
    buffer_store_dwordx4 v[72:75], v190, s[32:35], s40 offen sc1
    v_pk_mul_f32 v[76:77], v[76:77], v[230:231] op_sel_hi:[1,0]
    v_pk_mul_f32 v[78:79], v[78:79], v[230:231] op_sel_hi:[1,0]
    v_pk_mul_f32 v[88:89], v[88:89], v[230:231] op_sel_hi:[1,0]
    v_pk_mul_f32 v[90:91], v[90:91], v[230:231] op_sel_hi:[1,0]
    v_cvt_pk_bf16_f32 v76, v76, v77
    v_cvt_pk_bf16_f32 v77, v78, v79
    v_cvt_pk_bf16_f32 v78, v88, v89
    v_cvt_pk_bf16_f32 v79, v90, v91
    buffer_store_dwordx4 v[76:79], v190, s[32:35], s41 offen sc1
    v_pk_mul_f32 v[80:81], v[80:81], v[232:233] op_sel_hi:[1,0]
    v_pk_mul_f32 v[82:83], v[82:83], v[232:233] op_sel_hi:[1,0]
    v_pk_mul_f32 v[92:93], v[92:93], v[232:233] op_sel_hi:[1,0]
    v_pk_mul_f32 v[94:95], v[94:95], v[232:233] op_sel_hi:[1,0]
    v_cvt_pk_bf16_f32 v80, v80, v81
    v_cvt_pk_bf16_f32 v81, v82, v83
    v_cvt_pk_bf16_f32 v82, v92, v93
    v_cvt_pk_bf16_f32 v83, v94, v95
    buffer_store_dwordx4 v[80:83], v190, s[32:35], s42 offen sc1
    v_lshrrev_b32 v208, 2, v254
    v_and_b32 v209, 7, v208
    s_and_b32 s29, s7, 1
    s_lshl_b32 s30, s29, 2
    v_xor_b32 v209, s30, v209
    v_lshlrev_b32 v208, 8, v208
    v_lshl_add_u32 v208, v209, 5, v208
    v_and_b32 v209, 3, v254
    v_lshl_add_u32 v208, v209, 3, v208
    v_xor_b32 v192, 0, v208
    v_add_u32 v196, 73728, v192
    v_add_u32 v200, 114688, v192
    v_xor_b32 v193, 32, v208
    v_add_u32 v197, 73728, v193
    v_add_u32 v201, 114688, v193
    v_xor_b32 v194, 64, v208
    v_add_u32 v198, 73728, v194
    v_add_u32 v202, 114688, v194
    v_xor_b32 v195, 96, v208
    v_add_u32 v199, 73728, v195
    v_add_u32 v203, 114688, v195
    v_lshlrev_b32 v206, 4, v254
    s_lshl_b32 s30, s19, 12
    s_add_u32 s30, s30, 49152
    v_add_u32 v204, s30, v206
    v_add_u32 v205, 40960, v204
    s_cmp_lg_u32 s95, 1
    s_cselect_b32 s15, 1, 0
    s_mov_b32 s16, s15
    s_mov_b32 s13, 0
    s_mov_b32 s14, 0
    s_mov_b32 s31, 1000000
    s_cmp_eq_u32 s7, 0
    s_cbranch_scc1 L_FLAG
    s_waitcnt vmcnt(0)
    s_barrier
    s_branch L_NOFLAG
L_FLAG:
    s_mov_b64 exec, 1
    s_waitcnt vmcnt(0)
    s_barrier
    buffer_store_dword v252, v253, s[44:47], s100 offen sc1
    s_mov_b64 exec, -1
L_NOFLAG:
    s_cmp_eq_u32 s94, 15
    s_cbranch_scc1 L_FIN
L_POLL:
    s_cmp_lg_u32 s13, 0
    s_cbranch_scc1 L_PS0
    s_load_dword s13, s[10:11], s12 offset:0 glc
L_PS0:
    s_cmp_lg_u32 s14, 0
    s_cbranch_scc1 L_PS1
    s_load_dword s14, s[10:11], s12 offset:1024 glc
L_PS1:
    s_cmp_lg_u32 s15, 0
    s_cbranch_scc1 L_PS2
    s_load_dword s15, s[10:11], 8192 glc
L_PS2:
    s_cmp_lg_u32 s16, 0
    s_cbranch_scc1 L_PS3
    s_load_dword s16, s[10:11], 9216 glc
L_PS3:
    s_sub_u32 s31, s31, 1
    s_cbranch_scc1 L_GO
    s_waitcnt lgkmcnt(0)
    s_and_b32 s5, s13, s14
    s_and_b32 s30, s15, s16
    s_and_b32 s5, s5, s30
    s_cbranch_scc0 L_POLL
L_GO:
    s_barrier
    s_waitcnt lgkmcnt(0)
    s_mul_i32 s18, s99, 15
    s_lshl2_add_u32 s18, s94, s18
    s_lshl2_add_u32 s18, s18, s7
    s_mul_i32 s18, s18, 6144
    s_add_u32 s18, s18, 16777216
    s_add_u32 s32, s24, s18
    s_addc_u32 s33, s25, 0
    s_mov_b32 s34, 98304
    s_mov_b32 s35, 0x20000
    s_add_u32 s18, s97, 0
    s_and_b32 s18, s18, 3
    s_mul_i32 s18, s18, 24576
    s_add_u32 s36, s18, 0
    s_add_u32 s18, s97, 1
    s_and_b32 s18, s18, 3
    s_mul_i32 s18, s18, 24576
    s_add_u32 s37, s18, 0
    s_sub_u32 s18, s97, 1
    s_and_b32 s18, s18, 3
    s_mul_i32 s89, s18, 16384
    s_add_u32 s18, s97, 2
    s_and_b32 s18, s18, 3
    s_mul_i32 s18, s18, 24576
    s_add_u32 s38, s18, 2048
    s_sub_u32 s18, s97, 2
    s_and_b32 s18, s18, 3
    s_mul_i32 s90, s18, 16384
    s_add_u32 s18, s97, 3
    s_and_b32 s18, s18, 3
    s_mul_i32 s18, s18, 24576
    s_add_u32 s39, s18, 4096
    s_sub_u32 s18, s97, 3
    s_and_b32 s18, s18, 3
    s_mul_i32 s91, s18, 16384
    s_mul_i32 s18, s98, 3
    s_add_u32 s18, s18, s95
    s_lshl1_add_u32 s18, s18, s19
    s_lshl2_add_u32 s18, s18, s97
    s_mul_i32 s18, s18, 40960
    s_mul_i32 s30, s4, 1280
    s_add_u32 s18, s18, s30
    s_lshl1_add_u32 s30, s96, s29
    s_lshl_b32 s30, s30, 7
    s_add_u32 s18, s18, s30
    s_sub_u32 s30, 1966080, s18
    s_add_u32 s40, s20, s18
    s_addc_u32 s41, s21, 0
    s_mov_b32 s42, s30
    s_mov_b32 s43, 0x20000
    v_and_b32 v207, 15, v254
    v_mul_u32_u24 v207, 2560, v207
    v_and_b32 v208, 48, v254
    v_add_u32 v207, v207, v208
    ds_read_b64_tr_b16 v[64:65], v192 offset:0
    ds_read_b64_tr_b16 v[66:67], v192 offset:4096
    ds_read_b64_tr_b16 v[68:69], v192 offset:8192
    ds_read_b64_tr_b16 v[70:71], v192 offset:12288
    ds_read_b64_tr_b16 v[72:73], v193 offset:0
    ds_read_b64_tr_b16 v[74:75], v193 offset:4096
    ds_read_b64_tr_b16 v[76:77], v193 offset:8192
    ds_read_b64_tr_b16 v[78:79], v193 offset:12288
    ds_read_b64_tr_b16 v[80:81], v194 offset:0
    ds_read_b64_tr_b16 v[82:83], v194 offset:4096
    ds_read_b64_tr_b16 v[84:85], v194 offset:8192
    ds_read_b64_tr_b16 v[86:87], v194 offset:12288
    ds_read_b64_tr_b16 v[88:89], v195 offset:0
    ds_read_b64_tr_b16 v[90:91], v195 offset:4096
    ds_read_b64_tr_b16 v[92:93], v195 offset:8192
    ds_read_b64_tr_b16 v[94:95], v195 offset:12288
    ds_read_b64_tr_b16 v[96:97], v192 offset:16384
    ds_read_b64_tr_b16 v[98:99], v192 offset:20480
    ds_read_b64_tr_b16 v[100:101], v192 offset:24576
    ds_read_b64_tr_b16 v[102:103], v192 offset:28672
    ds_read_b64_tr_b16 v[104:105], v193 offset:16384
    ds_read_b64_tr_b16 v[106:107], v193 offset:20480
    ds_read_b64_tr_b16 v[108:109], v193 offset:24576
    ds_read_b64_tr_b16 v[110:111], v193 offset:28672
    ds_read_b64_tr_b16 v[112:113], v194 offset:16384
    ds_read_b64_tr_b16 v[114:115], v194 offset:20480
    ds_read_b64_tr_b16 v[116:117], v194 offset:24576
    ds_read_b64_tr_b16 v[118:119], v194 offset:28672
    ds_read_b64_tr_b16 v[120:121], v195 offset:16384
    ds_read_b64_tr_b16 v[122:123], v195 offset:20480
    ds_read_b64_tr_b16 v[124:125], v195 offset:24576
    ds_read_b64_tr_b16 v[126:127], v195 offset:28672
    s_waitcnt lgkmcnt(0)
    s_barrier
    ds_read_b128 v[128:131], v204 offset:0
    ds_read_b128 v[132:135], v205 offset:0
    ds_read_b128 v[136:139], v204 offset:1024
    ds_read_b128 v[140:143], v205 offset:1024
    ds_read_b128 v[144:147], v204 offset:2048
    ds_read_b128 v[148:151], v205 offset:2048
    ds_read_b128 v[152:155], v204 offset:3072
    ds_read_b128 v[156:159], v205 offset:3072
    s_waitcnt lgkmcnt(6)
    v_mfma_f32_16x16x32_bf16 v[0:3], v[64:67], v[128:131], 0
    v_mfma_f32_16x16x32_bf16 v[0:3], v[68:71], v[132:135], v[0:3]
    s_waitcnt lgkmcnt(4)
    v_mfma_f32_16x16x32_bf16 v[4:7], v[68:71], v[140:143], 0
    v_mfma_f32_16x16x32_bf16 v[4:7], v[64:67], v[136:139], v[4:7]
    s_waitcnt lgkmcnt(2)
    v_mfma_f32_16x16x32_bf16 v[8:11], v[64:67], v[144:147], 0
    v_mfma_f32_16x16x32_bf16 v[8:11], v[68:71], v[148:151], v[8:11]
    s_waitcnt lgkmcnt(0)
    s_barrier
    v_mfma_f32_16x16x32_bf16 v[12:15], v[68:71], v[156:159], 0
    ds_read_b128 v[160:163], v204 offset:8192
    v_mfma_f32_16x16x32_bf16 v[12:15], v[64:67], v[152:155], v[12:15]
    ds_read_b128 v[164:167], v205 offset:8192
    v_mfma_f32_16x16x32_bf16 v[28:31], v[72:75], v[152:155], 0
    ds_read_b128 v[168:171], v204 offset:9216
    v_mfma_f32_16x16x32_bf16 v[28:31], v[76:79], v[156:159], v[28:31]
    ds_read_b128 v[172:175], v205 offset:9216
    v_mfma_f32_16x16x32_bf16 v[24:27], v[76:79], v[148:151], 0
    ds_read_b128 v[176:179], v204 offset:10240
    v_mfma_f32_16x16x32_bf16 v[24:27], v[72:75], v[144:147], v[24:27]
    ds_read_b128 v[180:183], v205 offset:10240
    v_mfma_f32_16x16x32_bf16 v[20:23], v[72:75], v[136:139], 0
    ds_read_b128 v[184:187], v204 offset:11264
    v_mfma_f32_16x16x32_bf16 v[20:23], v[76:79], v[140:143], v[20:23]
    ds_read_b128 v[188:191], v205 offset:11264
    v_mfma_f32_16x16x32_bf16 v[16:19], v[76:79], v[132:135], 0
    v_mfma_f32_16x16x32_bf16 v[16:19], v[72:75], v[128:131], v[16:19]
    v_mfma_f32_16x16x32_bf16 v[32:35], v[80:83], v[128:131], 0
    v_mfma_f32_16x16x32_bf16 v[32:35], v[84:87], v[132:135], v[32:35]
    v_mfma_f32_16x16x32_bf16 v[36:39], v[84:87], v[140:143], 0
    v_mfma_f32_16x16x32_bf16 v[36:39], v[80:83], v[136:139], v[36:39]
    v_mfma_f32_16x16x32_bf16 v[40:43], v[80:83], v[144:147], 0
    v_mfma_f32_16x16x32_bf16 v[40:43], v[84:87], v[148:151], v[40:43]
    v_mfma_f32_16x16x32_bf16 v[44:47], v[84:87], v[156:159], 0
    v_mfma_f32_16x16x32_bf16 v[44:47], v[80:83], v[152:155], v[44:47]
    v_mfma_f32_16x16x32_bf16 v[60:63], v[88:91], v[152:155], 0
    v_mfma_f32_16x16x32_bf16 v[60:63], v[92:95], v[156:159], v[60:63]
    v_mfma_f32_16x16x32_bf16 v[56:59], v[92:95], v[148:151], 0
    v_mfma_f32_16x16x32_bf16 v[56:59], v[88:91], v[144:147], v[56:59]
    v_mfma_f32_16x16x32_bf16 v[52:55], v[88:91], v[136:139], 0
    v_mfma_f32_16x16x32_bf16 v[52:55], v[92:95], v[140:143], v[52:55]
    v_mfma_f32_16x16x32_bf16 v[48:51], v[92:95], v[132:135], 0
    v_mfma_f32_16x16x32_bf16 v[48:51], v[88:91], v[128:131], v[48:51]
    s_waitcnt lgkmcnt(0)
    v_mfma_f32_16x16x32_bf16 v[0:3], v[96:99], v[160:163], v[0:3]
    v_mfma_f32_16x16x32_bf16 v[0:3], v[100:103], v[164:167], v[0:3]
    v_mfma_f32_16x16x32_bf16 v[4:7], v[100:103], v[172:175], v[4:7]
    v_mfma_f32_16x16x32_bf16 v[4:7], v[96:99], v[168:171], v[4:7]
    v_mfma_f32_16x16x32_bf16 v[8:11], v[96:99], v[176:179], v[8:11]
    v_mfma_f32_16x16x32_bf16 v[8:11], v[100:103], v[180:183], v[8:11]
    s_waitcnt lgkmcnt(0)
    s_barrier
    v_mfma_f32_16x16x32_bf16 v[12:15], v[100:103], v[188:191], v[12:15]
    ds_read_b64_tr_b16 v[64:65], v192 offset:32768
    v_mfma_f32_16x16x32_bf16 v[12:15], v[96:99], v[184:187], v[12:15]
    ds_read_b64_tr_b16 v[66:67], v192 offset:36864
    v_mfma_f32_16x16x32_bf16 v[28:31], v[104:107], v[184:187], v[28:31]
    ds_read_b64_tr_b16 v[68:69], v192 offset:40960
    v_mfma_f32_16x16x32_bf16 v[28:31], v[108:111], v[188:191], v[28:31]
    ds_read_b64_tr_b16 v[70:71], v192 offset:45056
    v_mfma_f32_16x16x32_bf16 v[24:27], v[108:111], v[180:183], v[24:27]
    ds_read_b128 v[128:131], v204 offset:16384
    v_mfma_f32_16x16x32_bf16 v[24:27], v[104:107], v[176:179], v[24:27]
    ds_read_b128 v[132:135], v205 offset:16384
    v_mfma_f32_16x16x32_bf16 v[20:23], v[104:107], v[168:171], v[20:23]
    ds_read_b128 v[136:139], v204 offset:17408
    v_mfma_f32_16x16x32_bf16 v[20:23], v[108:111], v[172:175], v[20:23]
    ds_read_b128 v[140:143], v205 offset:17408
    v_mfma_f32_16x16x32_bf16 v[16:19], v[108:111], v[164:167], v[16:19]
    ds_read_b128 v[144:147], v204 offset:18432
    v_mfma_f32_16x16x32_bf16 v[16:19], v[104:107], v[160:163], v[16:19]
    ds_read_b128 v[148:151], v205 offset:18432
    v_mfma_f32_16x16x32_bf16 v[32:35], v[112:115], v[160:163], v[32:35]
    ds_read_b128 v[152:155], v204 offset:19456
    v_mfma_f32_16x16x32_bf16 v[32:35], v[116:119], v[164:167], v[32:35]
    ds_read_b128 v[156:159], v205 offset:19456
    v_mfma_f32_16x16x32_bf16 v[36:39], v[116:119], v[172:175], v[36:39]
    ds_read_b64_tr_b16 v[72:73], v193 offset:32768
    v_mfma_f32_16x16x32_bf16 v[36:39], v[112:115], v[168:171], v[36:39]
    ds_read_b64_tr_b16 v[74:75], v193 offset:36864
    v_mfma_f32_16x16x32_bf16 v[40:43], v[112:115], v[176:179], v[40:43]
    ds_read_b64_tr_b16 v[76:77], v193 offset:40960
    v_mfma_f32_16x16x32_bf16 v[40:43], v[116:119], v[180:183], v[40:43]
    ds_read_b64_tr_b16 v[78:79], v193 offset:45056
    v_mfma_f32_16x16x32_bf16 v[44:47], v[116:119], v[188:191], v[44:47]
    ds_read_b64_tr_b16 v[80:81], v194 offset:32768
    v_mfma_f32_16x16x32_bf16 v[44:47], v[112:115], v[184:187], v[44:47]
    ds_read_b64_tr_b16 v[82:83], v194 offset:36864
    v_mfma_f32_16x16x32_bf16 v[60:63], v[120:123], v[184:187], v[60:63]
    ds_read_b64_tr_b16 v[84:85], v194 offset:40960
    v_mfma_f32_16x16x32_bf16 v[60:63], v[124:127], v[188:191], v[60:63]
    ds_read_b64_tr_b16 v[86:87], v194 offset:45056
    v_mfma_f32_16x16x32_bf16 v[56:59], v[124:127], v[180:183], v[56:59]
    ds_read_b64_tr_b16 v[88:89], v195 offset:32768
    v_mfma_f32_16x16x32_bf16 v[56:59], v[120:123], v[176:179], v[56:59]
    ds_read_b64_tr_b16 v[90:91], v195 offset:36864
    v_mfma_f32_16x16x32_bf16 v[52:55], v[120:123], v[168:171], v[52:55]
    ds_read_b64_tr_b16 v[92:93], v195 offset:40960
    v_mfma_f32_16x16x32_bf16 v[52:55], v[124:127], v[172:175], v[52:55]
    ds_read_b64_tr_b16 v[94:95], v195 offset:45056
    v_mfma_f32_16x16x32_bf16 v[48:51], v[124:127], v[164:167], v[48:51]
    v_mfma_f32_16x16x32_bf16 v[48:51], v[120:123], v[160:163], v[48:51]
    s_waitcnt lgkmcnt(12)
    v_mfma_f32_16x16x32_bf16 v[0:3], v[64:67], v[128:131], v[0:3]
    v_mfma_f32_16x16x32_bf16 v[0:3], v[68:71], v[132:135], v[0:3]
    v_mfma_f32_16x16x32_bf16 v[4:7], v[68:71], v[140:143], v[4:7]
    v_mfma_f32_16x16x32_bf16 v[4:7], v[64:67], v[136:139], v[4:7]
    v_mfma_f32_16x16x32_bf16 v[8:11], v[64:67], v[144:147], v[8:11]
    v_mfma_f32_16x16x32_bf16 v[8:11], v[68:71], v[148:151], v[8:11]
    s_waitcnt lgkmcnt(0)
    s_barrier
    v_mfma_f32_16x16x32_bf16 v[12:15], v[68:71], v[156:159], v[12:15]
    ds_read_b64_tr_b16 v[96:97], v196 offset:0
    v_mfma_f32_16x16x32_bf16 v[12:15], v[64:67], v[152:155], v[12:15]
    ds_read_b64_tr_b16 v[98:99], v196 offset:4096
    v_mfma_f32_16x16x32_bf16 v[28:31], v[72:75], v[152:155], v[28:31]
    ds_read_b64_tr_b16 v[100:101], v196 offset:8192
    v_mfma_f32_16x16x32_bf16 v[28:31], v[76:79], v[156:159], v[28:31]
    ds_read_b64_tr_b16 v[102:103], v196 offset:12288
    v_mfma_f32_16x16x32_bf16 v[24:27], v[76:79], v[148:151], v[24:27]
    ds_read_b128 v[160:163], v204 offset:0
    v_mfma_f32_16x16x32_bf16 v[24:27], v[72:75], v[144:147], v[24:27]
    ds_read_b128 v[164:167], v205 offset:0
    v_mfma_f32_16x16x32_bf16 v[20:23], v[72:75], v[136:139], v[20:23]
    ds_read_b128 v[168:171], v204 offset:1024
    v_mfma_f32_16x16x32_bf16 v[20:23], v[76:79], v[140:143], v[20:23]
    ds_read_b128 v[172:175], v205 offset:1024
    v_mfma_f32_16x16x32_bf16 v[16:19], v[76:79], v[132:135], v[16:19]
    ds_read_b128 v[176:179], v204 offset:2048
    v_mfma_f32_16x16x32_bf16 v[16:19], v[72:75], v[128:131], v[16:19]
    ds_read_b128 v[180:183], v205 offset:2048
    v_mfma_f32_16x16x32_bf16 v[32:35], v[80:83], v[128:131], v[32:35]
    ds_read_b128 v[184:187], v204 offset:3072
    v_mfma_f32_16x16x32_bf16 v[32:35], v[84:87], v[132:135], v[32:35]
    ds_read_b128 v[188:191], v205 offset:3072
    v_mfma_f32_16x16x32_bf16 v[36:39], v[84:87], v[140:143], v[36:39]
    ds_read_b64_tr_b16 v[104:105], v197 offset:0
    v_mfma_f32_16x16x32_bf16 v[36:39], v[80:83], v[136:139], v[36:39]
    ds_read_b64_tr_b16 v[106:107], v197 offset:4096
    v_mfma_f32_16x16x32_bf16 v[40:43], v[80:83], v[144:147], v[40:43]
    ds_read_b64_tr_b16 v[108:109], v197 offset:8192
    v_mfma_f32_16x16x32_bf16 v[40:43], v[84:87], v[148:151], v[40:43]
    ds_read_b64_tr_b16 v[110:111], v197 offset:12288
    v_mfma_f32_16x16x32_bf16 v[44:47], v[84:87], v[156:159], v[44:47]
    ds_read_b64_tr_b16 v[112:113], v198 offset:0
    v_mfma_f32_16x16x32_bf16 v[44:47], v[80:83], v[152:155], v[44:47]
    ds_read_b64_tr_b16 v[114:115], v198 offset:4096
    v_mfma_f32_16x16x32_bf16 v[60:63], v[88:91], v[152:155], v[60:63]
    ds_read_b64_tr_b16 v[116:117], v198 offset:8192
    v_mfma_f32_16x16x32_bf16 v[60:63], v[92:95], v[156:159], v[60:63]
    ds_read_b64_tr_b16 v[118:119], v198 offset:12288
    v_mfma_f32_16x16x32_bf16 v[56:59], v[92:95], v[148:151], v[56:59]
    ds_read_b64_tr_b16 v[120:121], v199 offset:0
    v_mfma_f32_16x16x32_bf16 v[56:59], v[88:91], v[144:147], v[56:59]
    ds_read_b64_tr_b16 v[122:123], v199 offset:4096
    v_mfma_f32_16x16x32_bf16 v[52:55], v[88:91], v[136:139], v[52:55]
    ds_read_b64_tr_b16 v[124:125], v199 offset:8192
    v_mfma_f32_16x16x32_bf16 v[52:55], v[92:95], v[140:143], v[52:55]
    ds_read_b64_tr_b16 v[126:127], v199 offset:12288
    v_mfma_f32_16x16x32_bf16 v[48:51], v[92:95], v[132:135], v[48:51]
    v_mfma_f32_16x16x32_bf16 v[48:51], v[88:91], v[128:131], v[48:51]
    s_waitcnt lgkmcnt(12)
    v_mfma_f32_16x16x32_bf16 v[0:3], v[96:99], v[160:163], v[0:3]
    v_mfma_f32_16x16x32_bf16 v[0:3], v[100:103], v[164:167], v[0:3]
    v_mfma_f32_16x16x32_bf16 v[4:7], v[100:103], v[172:175], v[4:7]
    v_mfma_f32_16x16x32_bf16 v[4:7], v[96:99], v[168:171], v[4:7]
    v_mfma_f32_16x16x32_bf16 v[8:11], v[96:99], v[176:179], v[8:11]
    v_mfma_f32_16x16x32_bf16 v[8:11], v[100:103], v[180:183], v[8:11]
    s_waitcnt lgkmcnt(0)
    s_barrier
    v_mfma_f32_16x16x32_bf16 v[12:15], v[100:103], v[188:191], v[12:15]
    ds_read_b64_tr_b16 v[64:65], v200 offset:0
    v_mfma_f32_16x16x32_bf16 v[12:15], v[96:99], v[184:187], v[12:15]
    ds_read_b64_tr_b16 v[66:67], v200 offset:4096
    v_mfma_f32_16x16x32_bf16 v[28:31], v[104:107], v[184:187], v[28:31]
    ds_read_b64_tr_b16 v[68:69], v200 offset:8192
    v_mfma_f32_16x16x32_bf16 v[28:31], v[108:111], v[188:191], v[28:31]
    ds_read_b64_tr_b16 v[70:71], v200 offset:12288
    v_mfma_f32_16x16x32_bf16 v[24:27], v[108:111], v[180:183], v[24:27]
    ds_read_b128 v[128:131], v204 offset:8192
    v_mfma_f32_16x16x32_bf16 v[24:27], v[104:107], v[176:179], v[24:27]
    ds_read_b128 v[132:135], v205 offset:8192
    v_mfma_f32_16x16x32_bf16 v[20:23], v[104:107], v[168:171], v[20:23]
    ds_read_b128 v[136:139], v204 offset:9216
    v_mfma_f32_16x16x32_bf16 v[20:23], v[108:111], v[172:175], v[20:23]
    ds_read_b128 v[140:143], v205 offset:9216
    v_mfma_f32_16x16x32_bf16 v[16:19], v[108:111], v[164:167], v[16:19]
    ds_read_b128 v[144:147], v204 offset:10240
    v_mfma_f32_16x16x32_bf16 v[16:19], v[104:107], v[160:163], v[16:19]
    ds_read_b128 v[148:151], v205 offset:10240
    v_mfma_f32_16x16x32_bf16 v[32:35], v[112:115], v[160:163], v[32:35]
    ds_read_b128 v[152:155], v204 offset:11264
    v_mfma_f32_16x16x32_bf16 v[32:35], v[116:119], v[164:167], v[32:35]
    ds_read_b128 v[156:159], v205 offset:11264
    v_mfma_f32_16x16x32_bf16 v[36:39], v[116:119], v[172:175], v[36:39]
    ds_read_b64_tr_b16 v[72:73], v201 offset:0
    v_mfma_f32_16x16x32_bf16 v[36:39], v[112:115], v[168:171], v[36:39]
    ds_read_b64_tr_b16 v[74:75], v201 offset:4096
    v_mfma_f32_16x16x32_bf16 v[40:43], v[112:115], v[176:179], v[40:43]
    ds_read_b64_tr_b16 v[76:77], v201 offset:8192
    v_mfma_f32_16x16x32_bf16 v[40:43], v[116:119], v[180:183], v[40:43]
    ds_read_b64_tr_b16 v[78:79], v201 offset:12288
    v_mfma_f32_16x16x32_bf16 v[44:47], v[116:119], v[188:191], v[44:47]
    ds_read_b64_tr_b16 v[80:81], v202 offset:0
    v_mfma_f32_16x16x32_bf16 v[44:47], v[112:115], v[184:187], v[44:47]
    ds_read_b64_tr_b16 v[82:83], v202 offset:4096
    v_mfma_f32_16x16x32_bf16 v[60:63], v[120:123], v[184:187], v[60:63]
    ds_read_b64_tr_b16 v[84:85], v202 offset:8192
    v_mfma_f32_16x16x32_bf16 v[60:63], v[124:127], v[188:191], v[60:63]
    ds_read_b64_tr_b16 v[86:87], v202 offset:12288
    v_mfma_f32_16x16x32_bf16 v[56:59], v[124:127], v[180:183], v[56:59]
    ds_read_b64_tr_b16 v[88:89], v203 offset:0
    v_mfma_f32_16x16x32_bf16 v[56:59], v[120:123], v[176:179], v[56:59]
    ds_read_b64_tr_b16 v[90:91], v203 offset:4096
    v_mfma_f32_16x16x32_bf16 v[52:55], v[120:123], v[168:171], v[52:55]
    ds_read_b64_tr_b16 v[92:93], v203 offset:8192
    v_mfma_f32_16x16x32_bf16 v[52:55], v[124:127], v[172:175], v[52:55]
    ds_read_b64_tr_b16 v[94:95], v203 offset:12288
    v_mfma_f32_16x16x32_bf16 v[48:51], v[124:127], v[164:167], v[48:51]
    v_mfma_f32_16x16x32_bf16 v[48:51], v[120:123], v[160:163], v[48:51]
    s_waitcnt lgkmcnt(12)
    v_mfma_f32_16x16x32_bf16 v[0:3], v[64:67], v[128:131], v[0:3]
    v_mfma_f32_16x16x32_bf16 v[0:3], v[68:71], v[132:135], v[0:3]
    v_mfma_f32_16x16x32_bf16 v[4:7], v[68:71], v[140:143], v[4:7]
    v_mfma_f32_16x16x32_bf16 v[4:7], v[64:67], v[136:139], v[4:7]
    v_mfma_f32_16x16x32_bf16 v[8:11], v[64:67], v[144:147], v[8:11]
    v_mfma_f32_16x16x32_bf16 v[8:11], v[68:71], v[148:151], v[8:11]
    s_waitcnt lgkmcnt(0)
    s_barrier
    v_mfma_f32_16x16x32_bf16 v[12:15], v[68:71], v[156:159], v[12:15]
    ds_read_b64_tr_b16 v[96:97], v200 offset:16384
    v_mfma_f32_16x16x32_bf16 v[12:15], v[64:67], v[152:155], v[12:15]
    ds_read_b64_tr_b16 v[98:99], v200 offset:20480
    v_mfma_f32_16x16x32_bf16 v[28:31], v[72:75], v[152:155], v[28:31]
    ds_read_b64_tr_b16 v[100:101], v200 offset:24576
    v_mfma_f32_16x16x32_bf16 v[28:31], v[76:79], v[156:159], v[28:31]
    ds_read_b64_tr_b16 v[102:103], v200 offset:28672
    v_mfma_f32_16x16x32_bf16 v[24:27], v[76:79], v[148:151], v[24:27]
    ds_read_b128 v[160:163], v204 offset:16384
    v_mfma_f32_16x16x32_bf16 v[24:27], v[72:75], v[144:147], v[24:27]
    ds_read_b128 v[164:167], v205 offset:16384
    v_mfma_f32_16x16x32_bf16 v[20:23], v[72:75], v[136:139], v[20:23]
    ds_read_b128 v[168:171], v204 offset:17408
    v_mfma_f32_16x16x32_bf16 v[20:23], v[76:79], v[140:143], v[20:23]
    ds_read_b128 v[172:175], v205 offset:17408
    v_mfma_f32_16x16x32_bf16 v[16:19], v[76:79], v[132:135], v[16:19]
    ds_read_b128 v[176:179], v204 offset:18432
    v_mfma_f32_16x16x32_bf16 v[16:19], v[72:75], v[128:131], v[16:19]
    ds_read_b128 v[180:183], v205 offset:18432
    v_mfma_f32_16x16x32_bf16 v[32:35], v[80:83], v[128:131], v[32:35]
    ds_read_b128 v[184:187], v204 offset:19456
    v_mfma_f32_16x16x32_bf16 v[32:35], v[84:87], v[132:135], v[32:35]
    ds_read_b128 v[188:191], v205 offset:19456
    v_mfma_f32_16x16x32_bf16 v[36:39], v[84:87], v[140:143], v[36:39]
    ds_read_b64_tr_b16 v[104:105], v201 offset:16384
    v_mfma_f32_16x16x32_bf16 v[36:39], v[80:83], v[136:139], v[36:39]
    ds_read_b64_tr_b16 v[106:107], v201 offset:20480
    v_mfma_f32_16x16x32_bf16 v[40:43], v[80:83], v[144:147], v[40:43]
    ds_read_b64_tr_b16 v[108:109], v201 offset:24576
    v_mfma_f32_16x16x32_bf16 v[40:43], v[84:87], v[148:151], v[40:43]
    ds_read_b64_tr_b16 v[110:111], v201 offset:28672
    v_mfma_f32_16x16x32_bf16 v[44:47], v[84:87], v[156:159], v[44:47]
    ds_read_b64_tr_b16 v[112:113], v202 offset:16384
    v_mfma_f32_16x16x32_bf16 v[44:47], v[80:83], v[152:155], v[44:47]
    ds_read_b64_tr_b16 v[114:115], v202 offset:20480
    v_mfma_f32_16x16x32_bf16 v[60:63], v[88:91], v[152:155], v[60:63]
    ds_read_b64_tr_b16 v[116:117], v202 offset:24576
    v_mfma_f32_16x16x32_bf16 v[60:63], v[92:95], v[156:159], v[60:63]
    ds_read_b64_tr_b16 v[118:119], v202 offset:28672
    v_mfma_f32_16x16x32_bf16 v[56:59], v[92:95], v[148:151], v[56:59]
    ds_read_b64_tr_b16 v[120:121], v203 offset:16384
    v_mfma_f32_16x16x32_bf16 v[56:59], v[88:91], v[144:147], v[56:59]
    ds_read_b64_tr_b16 v[122:123], v203 offset:20480
    v_mfma_f32_16x16x32_bf16 v[52:55], v[88:91], v[136:139], v[52:55]
    ds_read_b64_tr_b16 v[124:125], v203 offset:24576
    v_mfma_f32_16x16x32_bf16 v[52:55], v[92:95], v[140:143], v[52:55]
    ds_read_b64_tr_b16 v[126:127], v203 offset:28672
    v_mfma_f32_16x16x32_bf16 v[48:51], v[92:95], v[132:135], v[48:51]
    v_mfma_f32_16x16x32_bf16 v[48:51], v[88:91], v[128:131], v[48:51]
    s_waitcnt lgkmcnt(12)
    v_mfma_f32_16x16x32_bf16 v[0:3], v[96:99], v[160:163], v[0:3]
    v_mfma_f32_16x16x32_bf16 v[0:3], v[100:103], v[164:167], v[0:3]
    v_mfma_f32_16x16x32_bf16 v[4:7], v[100:103], v[172:175], v[4:7]
    v_mfma_f32_16x16x32_bf16 v[4:7], v[96:99], v[168:171], v[4:7]
    v_mfma_f32_16x16x32_bf16 v[8:11], v[96:99], v[176:179], v[8:11]
    v_mfma_f32_16x16x32_bf16 v[8:11], v[100:103], v[180:183], v[8:11]
    s_waitcnt lgkmcnt(0)
    s_barrier
    v_mfma_f32_16x16x32_bf16 v[12:15], v[100:103], v[188:191], v[12:15]
    ds_read_b64_tr_b16 v[64:65], v200 offset:32768
    v_mfma_f32_16x16x32_bf16 v[12:15], v[96:99], v[184:187], v[12:15]
    ds_read_b64_tr_b16 v[66:67], v200 offset:36864
    v_mfma_f32_16x16x32_bf16 v[28:31], v[104:107], v[184:187], v[28:31]
    ds_read_b64_tr_b16 v[68:69], v200 offset:40960
    v_mfma_f32_16x16x32_bf16 v[28:31], v[108:111], v[188:191], v[28:31]
    ds_read_b64_tr_b16 v[70:71], v200 offset:45056
    v_mfma_f32_16x16x32_bf16 v[24:27], v[108:111], v[180:183], v[24:27]
    ds_read_b128 v[128:131], v204 offset:0
    v_mfma_f32_16x16x32_bf16 v[24:27], v[104:107], v[176:179], v[24:27]
    ds_read_b128 v[132:135], v205 offset:0
    v_mfma_f32_16x16x32_bf16 v[20:23], v[104:107], v[168:171], v[20:23]
    ds_read_b128 v[136:139], v204 offset:1024
    v_mfma_f32_16x16x32_bf16 v[20:23], v[108:111], v[172:175], v[20:23]
    ds_read_b128 v[140:143], v205 offset:1024
    v_mfma_f32_16x16x32_bf16 v[16:19], v[108:111], v[164:167], v[16:19]
    ds_read_b128 v[144:147], v204 offset:2048
    v_mfma_f32_16x16x32_bf16 v[16:19], v[104:107], v[160:163], v[16:19]
    ds_read_b128 v[148:151], v205 offset:2048
    v_mfma_f32_16x16x32_bf16 v[32:35], v[112:115], v[160:163], v[32:35]
    ds_read_b128 v[152:155], v204 offset:3072
    v_mfma_f32_16x16x32_bf16 v[32:35], v[116:119], v[164:167], v[32:35]
    ds_read_b128 v[156:159], v205 offset:3072
    v_mfma_f32_16x16x32_bf16 v[36:39], v[116:119], v[172:175], v[36:39]
    ds_read_b64_tr_b16 v[72:73], v201 offset:32768
    v_mfma_f32_16x16x32_bf16 v[36:39], v[112:115], v[168:171], v[36:39]
    ds_read_b64_tr_b16 v[74:75], v201 offset:36864
    v_mfma_f32_16x16x32_bf16 v[40:43], v[112:115], v[176:179], v[40:43]
    ds_read_b64_tr_b16 v[76:77], v201 offset:40960
    v_mfma_f32_16x16x32_bf16 v[40:43], v[116:119], v[180:183], v[40:43]
    ds_read_b64_tr_b16 v[78:79], v201 offset:45056
    v_mfma_f32_16x16x32_bf16 v[44:47], v[116:119], v[188:191], v[44:47]
    ds_read_b64_tr_b16 v[80:81], v202 offset:32768
    v_mfma_f32_16x16x32_bf16 v[44:47], v[112:115], v[184:187], v[44:47]
    ds_read_b64_tr_b16 v[82:83], v202 offset:36864
    v_mfma_f32_16x16x32_bf16 v[60:63], v[120:123], v[184:187], v[60:63]
    ds_read_b64_tr_b16 v[84:85], v202 offset:40960
    v_mfma_f32_16x16x32_bf16 v[60:63], v[124:127], v[188:191], v[60:63]
    ds_read_b64_tr_b16 v[86:87], v202 offset:45056
    v_mfma_f32_16x16x32_bf16 v[56:59], v[124:127], v[180:183], v[56:59]
    ds_read_b64_tr_b16 v[88:89], v203 offset:32768
    v_mfma_f32_16x16x32_bf16 v[56:59], v[120:123], v[176:179], v[56:59]
    ds_read_b64_tr_b16 v[90:91], v203 offset:36864
    v_mfma_f32_16x16x32_bf16 v[52:55], v[120:123], v[168:171], v[52:55]
    ds_read_b64_tr_b16 v[92:93], v203 offset:40960
    v_mfma_f32_16x16x32_bf16 v[52:55], v[124:127], v[172:175], v[52:55]
    ds_read_b64_tr_b16 v[94:95], v203 offset:45056
    v_mfma_f32_16x16x32_bf16 v[48:51], v[124:127], v[164:167], v[48:51]
    v_mfma_f32_16x16x32_bf16 v[48:51], v[120:123], v[160:163], v[48:51]
    s_waitcnt lgkmcnt(12)
    v_mfma_f32_16x16x32_bf16 v[0:3], v[64:67], v[128:131], v[0:3]
    v_mfma_f32_16x16x32_bf16 v[0:3], v[68:71], v[132:135], v[0:3]
    v_mfma_f32_16x16x32_bf16 v[4:7], v[68:71], v[140:143], v[4:7]
    v_mfma_f32_16x16x32_bf16 v[4:7], v[64:67], v[136:139], v[4:7]
    v_mfma_f32_16x16x32_bf16 v[8:11], v[64:67], v[144:147], v[8:11]
    v_mfma_f32_16x16x32_bf16 v[8:11], v[68:71], v[148:151], v[8:11]
    s_waitcnt lgkmcnt(0)
    s_barrier
    v_mfma_f32_16x16x32_bf16 v[12:15], v[68:71], v[156:159], v[12:15]
    ds_read_b64_tr_b16 v[96:97], v192 offset:0
    v_mfma_f32_16x16x32_bf16 v[12:15], v[64:67], v[152:155], v[12:15]
    ds_read_b64_tr_b16 v[98:99], v192 offset:4096
    v_mfma_f32_16x16x32_bf16 v[28:31], v[72:75], v[152:155], v[28:31]
    ds_read_b64_tr_b16 v[100:101], v192 offset:8192
    v_mfma_f32_16x16x32_bf16 v[28:31], v[76:79], v[156:159], v[28:31]
    ds_read_b64_tr_b16 v[102:103], v192 offset:12288
    v_mfma_f32_16x16x32_bf16 v[24:27], v[76:79], v[148:151], v[24:27]
    ds_read_b128 v[160:163], v204 offset:8192
    v_mfma_f32_16x16x32_bf16 v[24:27], v[72:75], v[144:147], v[24:27]
    ds_read_b128 v[164:167], v205 offset:8192
    v_mfma_f32_16x16x32_bf16 v[20:23], v[72:75], v[136:139], v[20:23]
    ds_read_b128 v[168:171], v204 offset:9216
    v_mfma_f32_16x16x32_bf16 v[20:23], v[76:79], v[140:143], v[20:23]
    ds_read_b128 v[172:175], v205 offset:9216
    v_mfma_f32_16x16x32_bf16 v[16:19], v[76:79], v[132:135], v[16:19]
    ds_read_b128 v[176:179], v204 offset:10240
    v_mfma_f32_16x16x32_bf16 v[16:19], v[72:75], v[128:131], v[16:19]
    ds_read_b128 v[180:183], v205 offset:10240
    v_mfma_f32_16x16x32_bf16 v[32:35], v[80:83], v[128:131], v[32:35]
    ds_read_b128 v[184:187], v204 offset:11264
    v_mfma_f32_16x16x32_bf16 v[32:35], v[84:87], v[132:135], v[32:35]
    ds_read_b128 v[188:191], v205 offset:11264
    v_mfma_f32_16x16x32_bf16 v[36:39], v[84:87], v[140:143], v[36:39]
    ds_read_b64_tr_b16 v[104:105], v193 offset:0
    v_mfma_f32_16x16x32_bf16 v[36:39], v[80:83], v[136:139], v[36:39]
    ds_read_b64_tr_b16 v[106:107], v193 offset:4096
    v_mfma_f32_16x16x32_bf16 v[40:43], v[80:83], v[144:147], v[40:43]
    ds_read_b64_tr_b16 v[108:109], v193 offset:8192
    v_mfma_f32_16x16x32_bf16 v[40:43], v[84:87], v[148:151], v[40:43]
    ds_read_b64_tr_b16 v[110:111], v193 offset:12288
    v_mfma_f32_16x16x32_bf16 v[44:47], v[84:87], v[156:159], v[44:47]
    ds_read_b64_tr_b16 v[112:113], v194 offset:0
    v_mfma_f32_16x16x32_bf16 v[44:47], v[80:83], v[152:155], v[44:47]
    ds_read_b64_tr_b16 v[114:115], v194 offset:4096
    v_mfma_f32_16x16x32_bf16 v[60:63], v[88:91], v[152:155], v[60:63]
    ds_read_b64_tr_b16 v[116:117], v194 offset:8192
    v_mfma_f32_16x16x32_bf16 v[60:63], v[92:95], v[156:159], v[60:63]
    ds_read_b64_tr_b16 v[118:119], v194 offset:12288
    v_mfma_f32_16x16x32_bf16 v[56:59], v[92:95], v[148:151], v[56:59]
    ds_read_b64_tr_b16 v[120:121], v195 offset:0
    v_mfma_f32_16x16x32_bf16 v[56:59], v[88:91], v[144:147], v[56:59]
    ds_read_b64_tr_b16 v[122:123], v195 offset:4096
    v_mfma_f32_16x16x32_bf16 v[52:55], v[88:91], v[136:139], v[52:55]
    ds_read_b64_tr_b16 v[124:125], v195 offset:8192
    v_mfma_f32_16x16x32_bf16 v[52:55], v[92:95], v[140:143], v[52:55]
    ds_read_b64_tr_b16 v[126:127], v195 offset:12288
    v_mfma_f32_16x16x32_bf16 v[48:51], v[92:95], v[132:135], v[48:51]
    v_mfma_f32_16x16x32_bf16 v[48:51], v[88:91], v[128:131], v[48:51]
    s_waitcnt lgkmcnt(12)
    v_mfma_f32_16x16x32_bf16 v[0:3], v[96:99], v[160:163], v[0:3]
    v_mfma_f32_16x16x32_bf16 v[0:3], v[100:103], v[164:167], v[0:3]
    v_mfma_f32_16x16x32_bf16 v[4:7], v[100:103], v[172:175], v[4:7]
    v_mfma_f32_16x16x32_bf16 v[4:7], v[96:99], v[168:171], v[4:7]
    v_mfma_f32_16x16x32_bf16 v[8:11], v[96:99], v[176:179], v[8:11]
    v_mfma_f32_16x16x32_bf16 v[8:11], v[100:103], v[180:183], v[8:11]
    s_waitcnt lgkmcnt(0)
    s_barrier
    v_mfma_f32_16x16x32_bf16 v[12:15], v[100:103], v[188:191], v[12:15]
    ds_read_b64_tr_b16 v[64:65], v192 offset:16384
    v_mfma_f32_16x16x32_bf16 v[12:15], v[96:99], v[184:187], v[12:15]
    ds_read_b64_tr_b16 v[66:67], v192 offset:20480
    v_mfma_f32_16x16x32_bf16 v[28:31], v[104:107], v[184:187], v[28:31]
    ds_read_b64_tr_b16 v[68:69], v192 offset:24576
    v_mfma_f32_16x16x32_bf16 v[28:31], v[108:111], v[188:191], v[28:31]
    ds_read_b64_tr_b16 v[70:71], v192 offset:28672
    v_mfma_f32_16x16x32_bf16 v[24:27], v[108:111], v[180:183], v[24:27]
    ds_read_b128 v[128:131], v204 offset:16384
    v_mfma_f32_16x16x32_bf16 v[24:27], v[104:107], v[176:179], v[24:27]
    ds_read_b128 v[132:135], v205 offset:16384
    v_mfma_f32_16x16x32_bf16 v[20:23], v[104:107], v[168:171], v[20:23]
    ds_read_b128 v[136:139], v204 offset:17408
    v_mfma_f32_16x16x32_bf16 v[20:23], v[108:111], v[172:175], v[20:23]
    ds_read_b128 v[140:143], v205 offset:17408
    v_mfma_f32_16x16x32_bf16 v[16:19], v[108:111], v[164:167], v[16:19]
    ds_read_b128 v[144:147], v204 offset:18432
    v_mfma_f32_16x16x32_bf16 v[16:19], v[104:107], v[160:163], v[16:19]
    ds_read_b128 v[148:151], v205 offset:18432
    v_mfma_f32_16x16x32_bf16 v[32:35], v[112:115], v[160:163], v[32:35]
    ds_read_b128 v[152:155], v204 offset:19456
    v_mfma_f32_16x16x32_bf16 v[32:35], v[116:119], v[164:167], v[32:35]
    ds_read_b128 v[156:159], v205 offset:19456
    v_mfma_f32_16x16x32_bf16 v[36:39], v[116:119], v[172:175], v[36:39]
    ds_read_b64_tr_b16 v[72:73], v193 offset:16384
    v_mfma_f32_16x16x32_bf16 v[36:39], v[112:115], v[168:171], v[36:39]
    ds_read_b64_tr_b16 v[74:75], v193 offset:20480
    v_mfma_f32_16x16x32_bf16 v[40:43], v[112:115], v[176:179], v[40:43]
    ds_read_b64_tr_b16 v[76:77], v193 offset:24576
    v_mfma_f32_16x16x32_bf16 v[40:43], v[116:119], v[180:183], v[40:43]
    ds_read_b64_tr_b16 v[78:79], v193 offset:28672
    v_mfma_f32_16x16x32_bf16 v[44:47], v[116:119], v[188:191], v[44:47]
    ds_read_b64_tr_b16 v[80:81], v194 offset:16384
    v_mfma_f32_16x16x32_bf16 v[44:47], v[112:115], v[184:187], v[44:47]
    ds_read_b64_tr_b16 v[82:83], v194 offset:20480
    v_mfma_f32_16x16x32_bf16 v[60:63], v[120:123], v[184:187], v[60:63]
    ds_read_b64_tr_b16 v[84:85], v194 offset:24576
    v_mfma_f32_16x16x32_bf16 v[60:63], v[124:127], v[188:191], v[60:63]
    ds_read_b64_tr_b16 v[86:87], v194 offset:28672
    v_mfma_f32_16x16x32_bf16 v[56:59], v[124:127], v[180:183], v[56:59]
    ds_read_b64_tr_b16 v[88:89], v195 offset:16384
    v_mfma_f32_16x16x32_bf16 v[56:59], v[120:123], v[176:179], v[56:59]
    ds_read_b64_tr_b16 v[90:91], v195 offset:20480
    v_mfma_f32_16x16x32_bf16 v[52:55], v[120:123], v[168:171], v[52:55]
    ds_read_b64_tr_b16 v[92:93], v195 offset:24576
    v_mfma_f32_16x16x32_bf16 v[52:55], v[124:127], v[172:175], v[52:55]
    ds_read_b64_tr_b16 v[94:95], v195 offset:28672
    v_mfma_f32_16x16x32_bf16 v[48:51], v[124:127], v[164:167], v[48:51]
    v_mfma_f32_16x16x32_bf16 v[48:51], v[120:123], v[160:163], v[48:51]
    s_waitcnt lgkmcnt(12)
    v_mfma_f32_16x16x32_bf16 v[0:3], v[64:67], v[128:131], v[0:3]
    v_mfma_f32_16x16x32_bf16 v[0:3], v[68:71], v[132:135], v[0:3]
    v_mfma_f32_16x16x32_bf16 v[4:7], v[68:71], v[140:143], v[4:7]
    v_mfma_f32_16x16x32_bf16 v[4:7], v[64:67], v[136:139], v[4:7]
    v_mfma_f32_16x16x32_bf16 v[8:11], v[64:67], v[144:147], v[8:11]
    v_mfma_f32_16x16x32_bf16 v[8:11], v[68:71], v[148:151], v[8:11]
    s_waitcnt lgkmcnt(0)
    s_barrier
    v_mfma_f32_16x16x32_bf16 v[12:15], v[68:71], v[156:159], v[12:15]
    ds_read_b64_tr_b16 v[96:97], v192 offset:32768
    v_mfma_f32_16x16x32_bf16 v[12:15], v[64:67], v[152:155], v[12:15]
    ds_read_b64_tr_b16 v[98:99], v192 offset:36864
    v_mfma_f32_16x16x32_bf16 v[28:31], v[72:75], v[152:155], v[28:31]
    ds_read_b64_tr_b16 v[100:101], v192 offset:40960
    v_mfma_f32_16x16x32_bf16 v[28:31], v[76:79], v[156:159], v[28:31]
    ds_read_b64_tr_b16 v[102:103], v192 offset:45056
    v_mfma_f32_16x16x32_bf16 v[24:27], v[76:79], v[148:151], v[24:27]
    ds_read_b128 v[160:163], v204 offset:0
    v_mfma_f32_16x16x32_bf16 v[24:27], v[72:75], v[144:147], v[24:27]
    ds_read_b128 v[164:167], v205 offset:0
    v_mfma_f32_16x16x32_bf16 v[20:23], v[72:75], v[136:139], v[20:23]
    ds_read_b128 v[168:171], v204 offset:1024
    v_mfma_f32_16x16x32_bf16 v[20:23], v[76:79], v[140:143], v[20:23]
    ds_read_b128 v[172:175], v205 offset:1024
    v_mfma_f32_16x16x32_bf16 v[16:19], v[76:79], v[132:135], v[16:19]
    ds_read_b128 v[176:179], v204 offset:2048
    v_mfma_f32_16x16x32_bf16 v[16:19], v[72:75], v[128:131], v[16:19]
    ds_read_b128 v[180:183], v205 offset:2048
    v_mfma_f32_16x16x32_bf16 v[32:35], v[80:83], v[128:131], v[32:35]
    ds_read_b128 v[184:187], v204 offset:3072
    v_mfma_f32_16x16x32_bf16 v[32:35], v[84:87], v[132:135], v[32:35]
    ds_read_b128 v[188:191], v205 offset:3072
    v_mfma_f32_16x16x32_bf16 v[36:39], v[84:87], v[140:143], v[36:39]
    ds_read_b64_tr_b16 v[104:105], v193 offset:32768
    v_mfma_f32_16x16x32_bf16 v[36:39], v[80:83], v[136:139], v[36:39]
    ds_read_b64_tr_b16 v[106:107], v193 offset:36864
    v_mfma_f32_16x16x32_bf16 v[40:43], v[80:83], v[144:147], v[40:43]
    ds_read_b64_tr_b16 v[108:109], v193 offset:40960
    v_mfma_f32_16x16x32_bf16 v[40:43], v[84:87], v[148:151], v[40:43]
    ds_read_b64_tr_b16 v[110:111], v193 offset:45056
    v_mfma_f32_16x16x32_bf16 v[44:47], v[84:87], v[156:159], v[44:47]
    ds_read_b64_tr_b16 v[112:113], v194 offset:32768
    v_mfma_f32_16x16x32_bf16 v[44:47], v[80:83], v[152:155], v[44:47]
    ds_read_b64_tr_b16 v[114:115], v194 offset:36864
    v_mfma_f32_16x16x32_bf16 v[60:63], v[88:91], v[152:155], v[60:63]
    ds_read_b64_tr_b16 v[116:117], v194 offset:40960
    v_mfma_f32_16x16x32_bf16 v[60:63], v[92:95], v[156:159], v[60:63]
    ds_read_b64_tr_b16 v[118:119], v194 offset:45056
    v_mfma_f32_16x16x32_bf16 v[56:59], v[92:95], v[148:151], v[56:59]
    ds_read_b64_tr_b16 v[120:121], v195 offset:32768
    v_mfma_f32_16x16x32_bf16 v[56:59], v[88:91], v[144:147], v[56:59]
    ds_read_b64_tr_b16 v[122:123], v195 offset:36864
    v_mfma_f32_16x16x32_bf16 v[52:55], v[88:91], v[136:139], v[52:55]
    ds_read_b64_tr_b16 v[124:125], v195 offset:40960
    v_mfma_f32_16x16x32_bf16 v[52:55], v[92:95], v[140:143], v[52:55]
    ds_read_b64_tr_b16 v[126:127], v195 offset:45056
    v_mfma_f32_16x16x32_bf16 v[48:51], v[92:95], v[132:135], v[48:51]
    v_mfma_f32_16x16x32_bf16 v[48:51], v[88:91], v[128:131], v[48:51]
    s_waitcnt lgkmcnt(12)
    v_mfma_f32_16x16x32_bf16 v[0:3], v[96:99], v[160:163], v[0:3]
    v_mfma_f32_16x16x32_bf16 v[0:3], v[100:103], v[164:167], v[0:3]
    v_mfma_f32_16x16x32_bf16 v[4:7], v[100:103], v[172:175], v[4:7]
    v_mfma_f32_16x16x32_bf16 v[4:7], v[96:99], v[168:171], v[4:7]
    v_mfma_f32_16x16x32_bf16 v[8:11], v[96:99], v[176:179], v[8:11]
    v_mfma_f32_16x16x32_bf16 v[8:11], v[100:103], v[180:183], v[8:11]
    s_waitcnt lgkmcnt(0)
    s_barrier
    v_mfma_f32_16x16x32_bf16 v[12:15], v[100:103], v[188:191], v[12:15]
    ds_read_b64_tr_b16 v[64:65], v196 offset:0
    v_mfma_f32_16x16x32_bf16 v[12:15], v[96:99], v[184:187], v[12:15]
    ds_read_b64_tr_b16 v[66:67], v196 offset:4096
    v_mfma_f32_16x16x32_bf16 v[28:31], v[104:107], v[184:187], v[28:31]
    ds_read_b64_tr_b16 v[68:69], v196 offset:8192
    v_mfma_f32_16x16x32_bf16 v[28:31], v[108:111], v[188:191], v[28:31]
    ds_read_b64_tr_b16 v[70:71], v196 offset:12288
    v_mfma_f32_16x16x32_bf16 v[24:27], v[108:111], v[180:183], v[24:27]
    ds_read_b128 v[136:139], v204 offset:9216
    v_mfma_f32_16x16x32_bf16 v[24:27], v[104:107], v[176:179], v[24:27]
    ds_read_b128 v[140:143], v205 offset:9216
    v_mfma_f32_16x16x32_bf16 v[20:23], v[104:107], v[168:171], v[20:23]
    ds_read_b128 v[144:147], v204 offset:10240
    v_mfma_f32_16x16x32_bf16 v[20:23], v[108:111], v[172:175], v[20:23]
    ds_read_b128 v[148:151], v205 offset:10240
    v_mfma_f32_16x16x32_bf16 v[16:19], v[108:111], v[164:167], v[16:19]
    ds_read_b128 v[152:155], v204 offset:11264
    v_mfma_f32_16x16x32_bf16 v[16:19], v[104:107], v[160:163], v[16:19]
    ds_read_b128 v[156:159], v205 offset:11264
    v_mfma_f32_16x16x32_bf16 v[32:35], v[112:115], v[160:163], v[32:35]
    ds_read_b64_tr_b16 v[72:73], v197 offset:0
    v_mfma_f32_16x16x32_bf16 v[32:35], v[116:119], v[164:167], v[32:35]
    ds_read_b64_tr_b16 v[74:75], v197 offset:4096
    v_mfma_f32_16x16x32_bf16 v[36:39], v[116:119], v[172:175], v[36:39]
    ds_read_b64_tr_b16 v[76:77], v197 offset:8192
    v_mfma_f32_16x16x32_bf16 v[36:39], v[112:115], v[168:171], v[36:39]
    ds_read_b64_tr_b16 v[78:79], v197 offset:12288
    v_mfma_f32_16x16x32_bf16 v[40:43], v[112:115], v[176:179], v[40:43]
    ds_read_b64_tr_b16 v[80:81], v198 offset:0
    v_mfma_f32_16x16x32_bf16 v[40:43], v[116:119], v[180:183], v[40:43]
    ds_read_b64_tr_b16 v[82:83], v198 offset:4096
    v_mfma_f32_16x16x32_bf16 v[44:47], v[116:119], v[188:191], v[44:47]
    ds_read_b64_tr_b16 v[84:85], v198 offset:8192
    v_mfma_f32_16x16x32_bf16 v[44:47], v[112:115], v[184:187], v[44:47]
    ds_read_b64_tr_b16 v[86:87], v198 offset:12288
    v_mfma_f32_16x16x32_bf16 v[60:63], v[120:123], v[184:187], v[60:63]
    ds_read_b64_tr_b16 v[88:89], v199 offset:0
    v_mfma_f32_16x16x32_bf16 v[60:63], v[124:127], v[188:191], v[60:63]
    ds_read_b64_tr_b16 v[90:91], v199 offset:4096
    v_mfma_f32_16x16x32_bf16 v[56:59], v[124:127], v[180:183], v[56:59]
    ds_read_b64_tr_b16 v[92:93], v199 offset:8192
    v_mfma_f32_16x16x32_bf16 v[56:59], v[120:123], v[176:179], v[56:59]
    ds_read_b64_tr_b16 v[94:95], v199 offset:12288
    v_mfma_f32_16x16x32_bf16 v[52:55], v[120:123], v[168:171], v[52:55]
    v_mfma_f32_16x16x32_bf16 v[52:55], v[124:127], v[172:175], v[52:55]
    v_mfma_f32_16x16x32_bf16 v[48:51], v[124:127], v[164:167], v[48:51]
    v_mfma_f32_16x16x32_bf16 v[48:51], v[120:123], v[160:163], v[48:51]
    s_waitcnt lgkmcnt(12)
    v_mfma_f32_16x16x32_bf16 v[4:7], v[64:67], v[136:139], v[4:7]
    v_mfma_f32_16x16x32_bf16 v[4:7], v[68:71], v[140:143], v[4:7]
    s_barrier
    v_mfma_f32_16x16x32_bf16 v[8:11], v[68:71], v[148:151], v[8:11]
    ds_read_b64_tr_b16 v[96:97], v200 offset:0
    v_mfma_f32_16x16x32_bf16 v[8:11], v[64:67], v[144:147], v[8:11]
    ds_read_b64_tr_b16 v[98:99], v200 offset:4096
    v_mfma_f32_16x16x32_bf16 v[12:15], v[64:67], v[152:155], v[12:15]
    ds_read_b64_tr_b16 v[100:101], v200 offset:8192
    v_mfma_f32_16x16x32_bf16 v[12:15], v[68:71], v[156:159], v[12:15]
    ds_read_b64_tr_b16 v[102:103], v200 offset:12288
    s_waitcnt lgkmcnt(12)
    v_mfma_f32_16x16x32_bf16 v[28:31], v[76:79], v[156:159], v[28:31]
    ds_read_b128 v[168:171], v204 offset:17408
    v_mfma_f32_16x16x32_bf16 v[28:31], v[72:75], v[152:155], v[28:31]
    ds_read_b128 v[172:175], v205 offset:17408
    v_mfma_f32_16x16x32_bf16 v[24:27], v[72:75], v[144:147], v[24:27]
    ds_read_b128 v[176:179], v204 offset:18432
    v_mfma_f32_16x16x32_bf16 v[24:27], v[76:79], v[148:151], v[24:27]
    ds_read_b128 v[180:183], v205 offset:18432
    v_mfma_f32_16x16x32_bf16 v[20:23], v[76:79], v[140:143], v[20:23]
    ds_read_b128 v[184:187], v204 offset:19456
    v_mfma_f32_16x16x32_bf16 v[20:23], v[72:75], v[136:139], v[20:23]
    ds_read_b128 v[188:191], v205 offset:19456
    s_waitcnt lgkmcnt(14)
    v_mfma_f32_16x16x32_bf16 v[36:39], v[80:83], v[136:139], v[36:39]
    ds_read_b64_tr_b16 v[104:105], v201 offset:0
    v_mfma_f32_16x16x32_bf16 v[36:39], v[84:87], v[140:143], v[36:39]
    ds_read_b64_tr_b16 v[106:107], v201 offset:4096
    v_mfma_f32_16x16x32_bf16 v[40:43], v[84:87], v[148:151], v[40:43]
    ds_read_b64_tr_b16 v[108:109], v201 offset:8192
    v_mfma_f32_16x16x32_bf16 v[40:43], v[80:83], v[144:147], v[40:43]
    ds_read_b64_tr_b16 v[110:111], v201 offset:12288
    v_mfma_f32_16x16x32_bf16 v[44:47], v[80:83], v[152:155], v[44:47]
    ds_read_b64_tr_b16 v[112:113], v202 offset:0
    v_mfma_f32_16x16x32_bf16 v[44:47], v[84:87], v[156:159], v[44:47]
    ds_read_b64_tr_b16 v[114:115], v202 offset:4096
    s_waitcnt lgkmcnt(15)
    v_mfma_f32_16x16x32_bf16 v[60:63], v[92:95], v[156:159], v[60:63]
    ds_read_b64_tr_b16 v[116:117], v202 offset:8192
    v_mfma_f32_16x16x32_bf16 v[60:63], v[88:91], v[152:155], v[60:63]
    ds_read_b64_tr_b16 v[118:119], v202 offset:12288
    v_mfma_f32_16x16x32_bf16 v[56:59], v[88:91], v[144:147], v[56:59]
    ds_read_b64_tr_b16 v[120:121], v203 offset:0
    v_mfma_f32_16x16x32_bf16 v[56:59], v[92:95], v[148:151], v[56:59]
    ds_read_b64_tr_b16 v[122:123], v203 offset:4096
    v_mfma_f32_16x16x32_bf16 v[52:55], v[92:95], v[140:143], v[52:55]
    ds_read_b64_tr_b16 v[124:125], v203 offset:8192
    v_mfma_f32_16x16x32_bf16 v[52:55], v[88:91], v[136:139], v[52:55]
    ds_read_b64_tr_b16 v[126:127], v203 offset:12288
    s_waitcnt lgkmcnt(12)
    v_mfma_f32_16x16x32_bf16 v[4:7], v[96:99], v[168:171], v[4:7]
    v_mfma_f32_16x16x32_bf16 v[4:7], v[100:103], v[172:175], v[4:7]
    s_barrier
    v_mfma_f32_16x16x32_bf16 v[8:11], v[100:103], v[180:183], v[8:11]
    ds_read_b64_tr_b16 v[64:65], v200 offset:16384
    v_mfma_f32_16x16x32_bf16 v[8:11], v[96:99], v[176:179], v[8:11]
    ds_read_b64_tr_b16 v[66:67], v200 offset:20480
    v_mfma_f32_16x16x32_bf16 v[12:15], v[96:99], v[184:187], v[12:15]
    ds_read_b64_tr_b16 v[68:69], v200 offset:24576
    v_mfma_f32_16x16x32_bf16 v[12:15], v[100:103], v[188:191], v[12:15]
    ds_read_b64_tr_b16 v[70:71], v200 offset:28672
    s_waitcnt lgkmcnt(12)
    v_mfma_f32_16x16x32_bf16 v[28:31], v[108:111], v[188:191], v[28:31]
    ds_read_b128 v[136:139], v204 offset:1024
    v_mfma_f32_16x16x32_bf16 v[28:31], v[104:107], v[184:187], v[28:31]
    ds_read_b128 v[140:143], v205 offset:1024
    v_mfma_f32_16x16x32_bf16 v[24:27], v[104:107], v[176:179], v[24:27]
    ds_read_b128 v[144:147], v204 offset:2048
    v_mfma_f32_16x16x32_bf16 v[24:27], v[108:111], v[180:183], v[24:27]
    ds_read_b128 v[148:151], v205 offset:2048
    v_mfma_f32_16x16x32_bf16 v[20:23], v[108:111], v[172:175], v[20:23]
    ds_read_b128 v[152:155], v204 offset:3072
    v_mfma_f32_16x16x32_bf16 v[20:23], v[104:107], v[168:171], v[20:23]
    ds_read_b128 v[156:159], v205 offset:3072
    s_waitcnt lgkmcnt(14)
    v_mfma_f32_16x16x32_bf16 v[36:39], v[112:115], v[168:171], v[36:39]
    ds_read_b64_tr_b16 v[72:73], v201 offset:16384
    v_mfma_f32_16x16x32_bf16 v[36:39], v[116:119], v[172:175], v[36:39]
    ds_read_b64_tr_b16 v[74:75], v201 offset:20480
    v_mfma_f32_16x16x32_bf16 v[40:43], v[116:119], v[180:183], v[40:43]
    ds_read_b64_tr_b16 v[76:77], v201 offset:24576
    v_mfma_f32_16x16x32_bf16 v[40:43], v[112:115], v[176:179], v[40:43]
    ds_read_b64_tr_b16 v[78:79], v201 offset:28672
    v_mfma_f32_16x16x32_bf16 v[44:47], v[112:115], v[184:187], v[44:47]
    ds_read_b64_tr_b16 v[80:81], v202 offset:16384
    v_mfma_f32_16x16x32_bf16 v[44:47], v[116:119], v[188:191], v[44:47]
    ds_read_b64_tr_b16 v[82:83], v202 offset:20480
    s_waitcnt lgkmcnt(15)
    v_mfma_f32_16x16x32_bf16 v[60:63], v[124:127], v[188:191], v[60:63]
    ds_read_b64_tr_b16 v[84:85], v202 offset:24576
    v_mfma_f32_16x16x32_bf16 v[60:63], v[120:123], v[184:187], v[60:63]
    ds_read_b64_tr_b16 v[86:87], v202 offset:28672
    v_mfma_f32_16x16x32_bf16 v[56:59], v[120:123], v[176:179], v[56:59]
    ds_read_b64_tr_b16 v[88:89], v203 offset:16384
    v_mfma_f32_16x16x32_bf16 v[56:59], v[124:127], v[180:183], v[56:59]
    ds_read_b64_tr_b16 v[90:91], v203 offset:20480
    v_mfma_f32_16x16x32_bf16 v[52:55], v[124:127], v[172:175], v[52:55]
    ds_read_b64_tr_b16 v[92:93], v203 offset:24576
    v_mfma_f32_16x16x32_bf16 v[52:55], v[120:123], v[168:171], v[52:55]
    ds_read_b64_tr_b16 v[94:95], v203 offset:28672
    s_waitcnt lgkmcnt(12)
    v_mfma_f32_16x16x32_bf16 v[4:7], v[64:67], v[136:139], v[4:7]
    v_mfma_f32_16x16x32_bf16 v[4:7], v[68:71], v[140:143], v[4:7]
    s_barrier
    v_mfma_f32_16x16x32_bf16 v[8:11], v[68:71], v[148:151], v[8:11]
    ds_read_b64_tr_b16 v[96:97], v200 offset:32768
    v_mfma_f32_16x16x32_bf16 v[8:11], v[64:67], v[144:147], v[8:11]
    ds_read_b64_tr_b16 v[98:99], v200 offset:36864
    v_mfma_f32_16x16x32_bf16 v[12:15], v[64:67], v[152:155], v[12:15]
    ds_read_b64_tr_b16 v[100:101], v200 offset:40960
    v_mfma_f32_16x16x32_bf16 v[12:15], v[68:71], v[156:159], v[12:15]
    ds_read_b64_tr_b16 v[102:103], v200 offset:45056
    s_waitcnt lgkmcnt(12)
    v_mfma_f32_16x16x32_bf16 v[28:31], v[76:79], v[156:159], v[28:31]
    ds_read_b128 v[168:171], v204 offset:9216
    v_mfma_f32_16x16x32_bf16 v[28:31], v[72:75], v[152:155], v[28:31]
    ds_read_b128 v[172:175], v205 offset:9216
    v_mfma_f32_16x16x32_bf16 v[24:27], v[72:75], v[144:147], v[24:27]
    ds_read_b128 v[176:179], v204 offset:10240
    v_mfma_f32_16x16x32_bf16 v[24:27], v[76:79], v[148:151], v[24:27]
    ds_read_b128 v[180:183], v205 offset:10240
    v_mfma_f32_16x16x32_bf16 v[20:23], v[76:79], v[140:143], v[20:23]
    ds_read_b128 v[184:187], v204 offset:11264
    v_mfma_f32_16x16x32_bf16 v[20:23], v[72:75], v[136:139], v[20:23]
    ds_read_b128 v[188:191], v205 offset:11264
    s_waitcnt lgkmcnt(14)
    v_mfma_f32_16x16x32_bf16 v[36:39], v[80:83], v[136:139], v[36:39]
    ds_read_b64_tr_b16 v[104:105], v201 offset:32768
    v_mfma_f32_16x16x32_bf16 v[36:39], v[84:87], v[140:143], v[36:39]
    ds_read_b64_tr_b16 v[106:107], v201 offset:36864
    v_mfma_f32_16x16x32_bf16 v[40:43], v[84:87], v[148:151], v[40:43]
    ds_read_b64_tr_b16 v[108:109], v201 offset:40960
    v_mfma_f32_16x16x32_bf16 v[40:43], v[80:83], v[144:147], v[40:43]
    ds_read_b64_tr_b16 v[110:111], v201 offset:45056
    v_mfma_f32_16x16x32_bf16 v[44:47], v[80:83], v[152:155], v[44:47]
    ds_read_b64_tr_b16 v[112:113], v202 offset:32768
    v_mfma_f32_16x16x32_bf16 v[44:47], v[84:87], v[156:159], v[44:47]
    ds_read_b64_tr_b16 v[114:115], v202 offset:36864
    s_waitcnt lgkmcnt(15)
    v_mfma_f32_16x16x32_bf16 v[60:63], v[92:95], v[156:159], v[60:63]
    ds_read_b64_tr_b16 v[116:117], v202 offset:40960
    v_mfma_f32_16x16x32_bf16 v[60:63], v[88:91], v[152:155], v[60:63]
    ds_read_b64_tr_b16 v[118:119], v202 offset:45056
    v_mfma_f32_16x16x32_bf16 v[56:59], v[88:91], v[144:147], v[56:59]
    ds_read_b64_tr_b16 v[120:121], v203 offset:32768
    v_mfma_f32_16x16x32_bf16 v[56:59], v[92:95], v[148:151], v[56:59]
    ds_read_b64_tr_b16 v[122:123], v203 offset:36864
    v_mfma_f32_16x16x32_bf16 v[52:55], v[92:95], v[140:143], v[52:55]
    ds_read_b64_tr_b16 v[124:125], v203 offset:40960
    v_mfma_f32_16x16x32_bf16 v[52:55], v[88:91], v[136:139], v[52:55]
    ds_read_b64_tr_b16 v[126:127], v203 offset:45056
    s_waitcnt lgkmcnt(12)
    v_mfma_f32_16x16x32_bf16 v[4:7], v[96:99], v[168:171], v[4:7]
    v_mfma_f32_16x16x32_bf16 v[4:7], v[100:103], v[172:175], v[4:7]
    s_barrier
    v_mfma_f32_16x16x32_bf16 v[8:11], v[100:103], v[180:183], v[8:11]
    ds_read_b64_tr_b16 v[64:65], v192 offset:0
    v_mfma_f32_16x16x32_bf16 v[8:11], v[96:99], v[176:179], v[8:11]
    ds_read_b64_tr_b16 v[66:67], v192 offset:4096
    v_mfma_f32_16x16x32_bf16 v[12:15], v[96:99], v[184:187], v[12:15]
    ds_read_b64_tr_b16 v[68:69], v192 offset:8192
    v_mfma_f32_16x16x32_bf16 v[12:15], v[100:103], v[188:191], v[12:15]
    ds_read_b64_tr_b16 v[70:71], v192 offset:12288
    s_waitcnt lgkmcnt(12)
    v_mfma_f32_16x16x32_bf16 v[28:31], v[108:111], v[188:191], v[28:31]
    ds_read_b128 v[136:139], v204 offset:17408
    v_mfma_f32_16x16x32_bf16 v[28:31], v[104:107], v[184:187], v[28:31]
    ds_read_b128 v[140:143], v205 offset:17408
    v_mfma_f32_16x16x32_bf16 v[24:27], v[104:107], v[176:179], v[24:27]
    ds_read_b128 v[144:147], v204 offset:18432
    v_mfma_f32_16x16x32_bf16 v[24:27], v[108:111], v[180:183], v[24:27]
    ds_read_b128 v[148:151], v205 offset:18432
    v_mfma_f32_16x16x32_bf16 v[20:23], v[108:111], v[172:175], v[20:23]
    ds_read_b128 v[152:155], v204 offset:19456
    v_mfma_f32_16x16x32_bf16 v[20:23], v[104:107], v[168:171], v[20:23]
    ds_read_b128 v[156:159], v205 offset:19456
    s_waitcnt lgkmcnt(14)
    v_mfma_f32_16x16x32_bf16 v[36:39], v[112:115], v[168:171], v[36:39]
    ds_read_b64_tr_b16 v[72:73], v193 offset:0
    v_mfma_f32_16x16x32_bf16 v[36:39], v[116:119], v[172:175], v[36:39]
    ds_read_b64_tr_b16 v[74:75], v193 offset:4096
    v_mfma_f32_16x16x32_bf16 v[40:43], v[116:119], v[180:183], v[40:43]
    ds_read_b64_tr_b16 v[76:77], v193 offset:8192
    v_mfma_f32_16x16x32_bf16 v[40:43], v[112:115], v[176:179], v[40:43]
    ds_read_b64_tr_b16 v[78:79], v193 offset:12288
    v_mfma_f32_16x16x32_bf16 v[44:47], v[112:115], v[184:187], v[44:47]
    ds_read_b64_tr_b16 v[80:81], v194 offset:0
    v_mfma_f32_16x16x32_bf16 v[44:47], v[116:119], v[188:191], v[44:47]
    ds_read_b64_tr_b16 v[82:83], v194 offset:4096
    s_waitcnt lgkmcnt(15)
    v_mfma_f32_16x16x32_bf16 v[60:63], v[124:127], v[188:191], v[60:63]
    ds_read_b64_tr_b16 v[84:85], v194 offset:8192
    v_mfma_f32_16x16x32_bf16 v[60:63], v[120:123], v[184:187], v[60:63]
    ds_read_b64_tr_b16 v[86:87], v194 offset:12288
    v_mfma_f32_16x16x32_bf16 v[56:59], v[120:123], v[176:179], v[56:59]
    ds_read_b64_tr_b16 v[88:89], v195 offset:0
    v_mfma_f32_16x16x32_bf16 v[56:59], v[124:127], v[180:183], v[56:59]
    ds_read_b64_tr_b16 v[90:91], v195 offset:4096
    v_mfma_f32_16x16x32_bf16 v[52:55], v[124:127], v[172:175], v[52:55]
    ds_read_b64_tr_b16 v[92:93], v195 offset:8192
    v_mfma_f32_16x16x32_bf16 v[52:55], v[120:123], v[168:171], v[52:55]
    ds_read_b64_tr_b16 v[94:95], v195 offset:12288
    s_waitcnt lgkmcnt(12)
    v_mfma_f32_16x16x32_bf16 v[4:7], v[64:67], v[136:139], v[4:7]
    v_mfma_f32_16x16x32_bf16 v[4:7], v[68:71], v[140:143], v[4:7]
    s_barrier
    v_mfma_f32_16x16x32_bf16 v[8:11], v[68:71], v[148:151], v[8:11]
    ds_read_b64_tr_b16 v[96:97], v192 offset:16384
    v_mfma_f32_16x16x32_bf16 v[8:11], v[64:67], v[144:147], v[8:11]
    ds_read_b64_tr_b16 v[98:99], v192 offset:20480
    v_mfma_f32_16x16x32_bf16 v[12:15], v[64:67], v[152:155], v[12:15]
    ds_read_b64_tr_b16 v[100:101], v192 offset:24576
    v_mfma_f32_16x16x32_bf16 v[12:15], v[68:71], v[156:159], v[12:15]
    ds_read_b64_tr_b16 v[102:103], v192 offset:28672
    s_waitcnt lgkmcnt(12)
    v_mfma_f32_16x16x32_bf16 v[28:31], v[76:79], v[156:159], v[28:31]
    ds_read_b128 v[168:171], v204 offset:1024
    v_mfma_f32_16x16x32_bf16 v[28:31], v[72:75], v[152:155], v[28:31]
    ds_read_b128 v[172:175], v205 offset:1024
    v_mfma_f32_16x16x32_bf16 v[24:27], v[72:75], v[144:147], v[24:27]
    ds_read_b128 v[176:179], v204 offset:2048
    v_mfma_f32_16x16x32_bf16 v[24:27], v[76:79], v[148:151], v[24:27]
    ds_read_b128 v[180:183], v205 offset:2048
    v_mfma_f32_16x16x32_bf16 v[20:23], v[76:79], v[140:143], v[20:23]
    ds_read_b128 v[184:187], v204 offset:3072
    v_mfma_f32_16x16x32_bf16 v[20:23], v[72:75], v[136:139], v[20:23]
    ds_read_b128 v[188:191], v205 offset:3072
    s_waitcnt lgkmcnt(14)
    v_mfma_f32_16x16x32_bf16 v[36:39], v[80:83], v[136:139], v[36:39]
    ds_read_b64_tr_b16 v[104:105], v193 offset:16384
    v_mfma_f32_16x16x32_bf16 v[36:39], v[84:87], v[140:143], v[36:39]
    ds_read_b64_tr_b16 v[106:107], v193 offset:20480
    v_mfma_f32_16x16x32_bf16 v[40:43], v[84:87], v[148:151], v[40:43]
    ds_read_b64_tr_b16 v[108:109], v193 offset:24576
    v_mfma_f32_16x16x32_bf16 v[40:43], v[80:83], v[144:147], v[40:43]
    ds_read_b64_tr_b16 v[110:111], v193 offset:28672
    v_mfma_f32_16x16x32_bf16 v[44:47], v[80:83], v[152:155], v[44:47]
    ds_read_b128 v[128:131], v204 offset:16384
    v_mfma_f32_16x16x32_bf16 v[44:47], v[84:87], v[156:159], v[44:47]
    ds_read_b128 v[132:135], v205 offset:16384
    s_waitcnt lgkmcnt(15)
    v_mfma_f32_16x16x32_bf16 v[60:63], v[92:95], v[156:159], v[60:63]
    v_mfma_f32_16x16x32_bf16 v[60:63], v[88:91], v[152:155], v[60:63]
    v_mfma_f32_16x16x32_bf16 v[56:59], v[88:91], v[144:147], v[56:59]
    v_mfma_f32_16x16x32_bf16 v[56:59], v[92:95], v[148:151], v[56:59]
    v_mfma_f32_16x16x32_bf16 v[52:55], v[92:95], v[140:143], v[52:55]
    v_mfma_f32_16x16x32_bf16 v[52:55], v[88:91], v[136:139], v[52:55]
    s_waitcnt lgkmcnt(10)
    v_mfma_f32_16x16x32_bf16 v[4:7], v[96:99], v[168:171], v[4:7]
    ds_read_b64_tr_b16 v[112:113], v194 offset:16384
    v_mfma_f32_16x16x32_bf16 v[4:7], v[100:103], v[172:175], v[4:7]
    ds_read_b64_tr_b16 v[114:115], v194 offset:20480
    s_waitcnt lgkmcnt(4)
    v_mfma_f32_16x16x32_bf16 v[20:23], v[108:111], v[172:175], v[20:23]
    ds_read_b64_tr_b16 v[116:117], v194 offset:24576
    v_mfma_f32_16x16x32_bf16 v[20:23], v[104:107], v[168:171], v[20:23]
    ds_read_b64_tr_b16 v[118:119], v194 offset:28672
    v_mfma_f32_16x16x32_bf16 v[8:11], v[96:99], v[176:179], v[8:11]
    ds_read_b64_tr_b16 v[120:121], v195 offset:16384
    v_mfma_f32_16x16x32_bf16 v[8:11], v[100:103], v[180:183], v[8:11]
    ds_read_b64_tr_b16 v[122:123], v195 offset:20480
    v_mfma_f32_16x16x32_bf16 v[24:27], v[108:111], v[180:183], v[24:27]
    ds_read_b64_tr_b16 v[124:125], v195 offset:24576
    v_cvt_pk_bf16_f32 v4, v4, v5
    v_mfma_f32_16x16x32_bf16 v[24:27], v[104:107], v[176:179], v[24:27]
    ds_read_b64_tr_b16 v[126:127], v195 offset:28672
    v_cvt_pk_bf16_f32 v5, v6, v7
    v_mfma_f32_16x16x32_bf16 v[12:15], v[96:99], v[184:187], v[12:15]
    ds_read_b128 v[160:163], v204 offset:0
    v_cvt_pk_bf16_f32 v6, v20, v21
    v_mfma_f32_16x16x32_bf16 v[12:15], v[100:103], v[188:191], v[12:15]
    ds_read_b128 v[164:167], v205 offset:0
    v_cvt_pk_bf16_f32 v7, v22, v23
    v_mfma_f32_16x16x32_bf16 v[28:31], v[108:111], v[188:191], v[28:31]
    buffer_store_dwordx4 v[4:7], v206, s[32:35], s37 offen offset:0 sc1
    v_cvt_pk_bf16_f32 v8, v8, v9
    v_mfma_f32_16x16x32_bf16 v[28:31], v[104:107], v[184:187], v[28:31]
    v_cvt_pk_bf16_f32 v9, v10, v11
    v_cvt_pk_bf16_f32 v10, v24, v25
    s_waitcnt lgkmcnt(6)
    v_mfma_f32_16x16x32_bf16 v[36:39], v[112:115], v[168:171], v[36:39]
    v_cvt_pk_bf16_f32 v11, v26, v27
    buffer_store_dwordx4 v[8:11], v206, s[32:35], s38 offen offset:0 sc1
    v_mfma_f32_16x16x32_bf16 v[36:39], v[116:119], v[172:175], v[36:39]
    s_waitcnt lgkmcnt(2)
    v_mfma_f32_16x16x32_bf16 v[52:55], v[124:127], v[172:175], v[52:55]
    v_cvt_pk_bf16_f32 v12, v12, v13
    v_cvt_pk_bf16_f32 v13, v14, v15
    v_mfma_f32_16x16x32_bf16 v[52:55], v[120:123], v[168:171], v[52:55]
    v_cvt_pk_bf16_f32 v14, v28, v29
    v_cvt_pk_bf16_f32 v15, v30, v31
    v_mfma_f32_16x16x32_bf16 v[40:43], v[112:115], v[176:179], v[40:43]
    buffer_store_dwordx4 v[12:15], v206, s[32:35], s39 offen offset:0 sc1
    v_mfma_f32_16x16x32_bf16 v[40:43], v[116:119], v[180:183], v[40:43]
    v_mfma_f32_16x16x32_bf16 v[56:59], v[124:127], v[180:183], v[56:59]
    v_cvt_pk_bf16_f32 v36, v36, v37
    v_cvt_pk_bf16_f32 v37, v38, v39
    v_mfma_f32_16x16x32_bf16 v[56:59], v[120:123], v[176:179], v[56:59]
    v_cvt_pk_bf16_f32 v38, v52, v53
    v_cvt_pk_bf16_f32 v39, v54, v55
    v_mfma_f32_16x16x32_bf16 v[44:47], v[112:115], v[184:187], v[44:47]
    buffer_store_dwordx4 v[36:39], v206, s[32:35], s37 offen offset:1024 sc1
    v_mfma_f32_16x16x32_bf16 v[44:47], v[116:119], v[188:191], v[44:47]
    v_mfma_f32_16x16x32_bf16 v[60:63], v[124:127], v[188:191], v[60:63]
    v_cvt_pk_bf16_f32 v40, v40, v41
    v_cvt_pk_bf16_f32 v41, v42, v43
    v_mfma_f32_16x16x32_bf16 v[60:63], v[120:123], v[184:187], v[60:63]
    v_cvt_pk_bf16_f32 v42, v56, v57
    v_cvt_pk_bf16_f32 v43, v58, v59
    v_mfma_f32_16x16x32_bf16 v[0:3], v[64:67], v[128:131], v[0:3]
    buffer_store_dwordx4 v[40:43], v206, s[32:35], s38 offen offset:1024 sc1
    v_mfma_f32_16x16x32_bf16 v[0:3], v[68:71], v[132:135], v[0:3]
    v_mfma_f32_16x16x32_bf16 v[16:19], v[76:79], v[132:135], v[16:19]
    v_cvt_pk_bf16_f32 v44, v44, v45
    v_cvt_pk_bf16_f32 v45, v46, v47
    v_mfma_f32_16x16x32_bf16 v[16:19], v[72:75], v[128:131], v[16:19]
    v_cvt_pk_bf16_f32 v46, v60, v61
    v_cvt_pk_bf16_f32 v47, v62, v63
    v_mfma_f32_16x16x32_bf16 v[32:35], v[80:83], v[128:131], v[32:35]
    buffer_store_dwordx4 v[44:47], v206, s[32:35], s39 offen offset:1024 sc1
    v_mfma_f32_16x16x32_bf16 v[32:35], v[84:87], v[132:135], v[32:35]
    s_barrier
    ds_read_b128 v[212:215], v204 offset:8192
    ds_read_b128 v[216:219], v205 offset:8192
    v_mfma_f32_16x16x32_bf16 v[48:51], v[92:95], v[132:135], v[48:51]
    ds_read_b128 v[220:223], v204 offset:9216
    ds_read_b128 v[224:227], v205 offset:9216
    v_mfma_f32_16x16x32_bf16 v[48:51], v[88:91], v[128:131], v[48:51]
    ds_read_b128 v[228:231], v204 offset:10240
    ds_read_b128 v[232:235], v205 offset:10240
    s_waitcnt lgkmcnt(6)
    v_mfma_f32_16x16x32_bf16 v[0:3], v[96:99], v[160:163], v[0:3]
    ds_read_b128 v[236:239], v204 offset:11264
    ds_read_b128 v[240:243], v205 offset:11264
    v_mfma_f32_16x16x32_bf16 v[0:3], v[100:103], v[164:167], v[0:3]
    ds_read_b64_tr_b16 v[64:65], v196 offset:0
    ds_read_b64_tr_b16 v[66:67], v196 offset:4096
    v_mfma_f32_16x16x32_bf16 v[16:19], v[108:111], v[164:167], v[16:19]
    ds_read_b64_tr_b16 v[68:69], v196 offset:8192
    ds_read_b64_tr_b16 v[70:71], v196 offset:12288
    v_mfma_f32_16x16x32_bf16 v[16:19], v[104:107], v[160:163], v[16:19]
    ds_read_b64_tr_b16 v[72:73], v197 offset:0
    ds_read_b64_tr_b16 v[74:75], v197 offset:4096
    v_mfma_f32_16x16x32_bf16 v[32:35], v[112:115], v[160:163], v[32:35]
    ds_read_b64_tr_b16 v[76:77], v197 offset:8192
    ds_read_b64_tr_b16 v[78:79], v197 offset:12288
    v_mfma_f32_16x16x32_bf16 v[32:35], v[116:119], v[164:167], v[32:35]
    ds_read_b64_tr_b16 v[80:81], v198 offset:0
    ds_read_b64_tr_b16 v[82:83], v198 offset:4096
    v_mfma_f32_16x16x32_bf16 v[48:51], v[124:127], v[164:167], v[48:51]
    ds_read_b64_tr_b16 v[84:85], v198 offset:8192
    ds_read_b64_tr_b16 v[86:87], v198 offset:12288
    v_mfma_f32_16x16x32_bf16 v[48:51], v[120:123], v[160:163], v[48:51]
    ds_read_b64_tr_b16 v[88:89], v199 offset:0
    ds_read_b64_tr_b16 v[90:91], v199 offset:4096
    ds_read_b64_tr_b16 v[92:93], v199 offset:8192
    ds_read_b64_tr_b16 v[94:95], v199 offset:12288
    s_waitcnt lgkmcnt(12)
    v_mfma_f32_16x16x32_bf16 v[0:3], v[64:67], v[212:215], v[0:3]
    ds_read_b64_tr_b16 v[96:97], v200 offset:0
    ds_read_b64_tr_b16 v[98:99], v200 offset:4096
    v_mfma_f32_16x16x32_bf16 v[0:3], v[68:71], v[216:219], v[0:3]
    ds_read_b64_tr_b16 v[100:101], v200 offset:8192
    ds_read_b64_tr_b16 v[102:103], v200 offset:12288
    s_waitcnt lgkmcnt(12)
    v_mfma_f32_16x16x32_bf16 v[16:19], v[72:75], v[212:215], v[16:19]
    ds_read_b64_tr_b16 v[104:105], v201 offset:0
    ds_read_b64_tr_b16 v[106:107], v201 offset:4096
    v_mfma_f32_16x16x32_bf16 v[16:19], v[76:79], v[216:219], v[16:19]
    ds_read_b64_tr_b16 v[108:109], v201 offset:8192
    ds_read_b64_tr_b16 v[110:111], v201 offset:12288
    s_waitcnt lgkmcnt(12)
    v_mfma_f32_16x16x32_bf16 v[32:35], v[80:83], v[212:215], v[32:35]
    ds_read_b64_tr_b16 v[112:113], v202 offset:0
    ds_read_b64_tr_b16 v[114:115], v202 offset:4096
    v_mfma_f32_16x16x32_bf16 v[32:35], v[84:87], v[216:219], v[32:35]
    ds_read_b64_tr_b16 v[116:117], v202 offset:8192
    ds_read_b64_tr_b16 v[118:119], v202 offset:12288
    s_waitcnt lgkmcnt(12)
    v_mfma_f32_16x16x32_bf16 v[48:51], v[88:91], v[212:215], v[48:51]
    ds_read_b64_tr_b16 v[120:121], v203 offset:0
    ds_read_b64_tr_b16 v[122:123], v203 offset:4096
    v_mfma_f32_16x16x32_bf16 v[48:51], v[92:95], v[216:219], v[48:51]
    ds_read_b64_tr_b16 v[124:125], v203 offset:8192
    ds_read_b64_tr_b16 v[126:127], v203 offset:12288
    s_waitcnt lgkmcnt(12)
    v_mfma_f32_16x16x32_bf16 v[0:3], v[96:99], v[220:223], v[0:3]
    ds_read_b64_tr_b16 v[64:65], v200 offset:16384
    ds_read_b64_tr_b16 v[66:67], v200 offset:20480
    v_mfma_f32_16x16x32_bf16 v[0:3], v[100:103], v[224:227], v[0:3]
    ds_read_b64_tr_b16 v[68:69], v200 offset:24576
    ds_read_b64_tr_b16 v[70:71], v200 offset:28672
    s_waitcnt lgkmcnt(12)
    v_mfma_f32_16x16x32_bf16 v[16:19], v[104:107], v[220:223], v[16:19]
    ds_read_b64_tr_b16 v[72:73], v201 offset:16384
    ds_read_b64_tr_b16 v[74:75], v201 offset:20480
    v_mfma_f32_16x16x32_bf16 v[16:19], v[108:111], v[224:227], v[16:19]
    ds_read_b64_tr_b16 v[76:77], v201 offset:24576
    ds_read_b64_tr_b16 v[78:79], v201 offset:28672
    s_waitcnt lgkmcnt(12)
    v_mfma_f32_16x16x32_bf16 v[32:35], v[112:115], v[220:223], v[32:35]
    ds_read_b64_tr_b16 v[80:81], v202 offset:16384
    ds_read_b64_tr_b16 v[82:83], v202 offset:20480
    v_mfma_f32_16x16x32_bf16 v[32:35], v[116:119], v[224:227], v[32:35]
    ds_read_b64_tr_b16 v[84:85], v202 offset:24576
    ds_read_b64_tr_b16 v[86:87], v202 offset:28672
    s_waitcnt lgkmcnt(12)
    v_mfma_f32_16x16x32_bf16 v[48:51], v[120:123], v[220:223], v[48:51]
    ds_read_b64_tr_b16 v[88:89], v203 offset:16384
    ds_read_b64_tr_b16 v[90:91], v203 offset:20480
    v_mfma_f32_16x16x32_bf16 v[48:51], v[124:127], v[224:227], v[48:51]
    ds_read_b64_tr_b16 v[92:93], v203 offset:24576
    ds_read_b64_tr_b16 v[94:95], v203 offset:28672
    s_add_u32 s37, s36, 4096
    s_mov_b64 exec, 1
    s_waitcnt vmcnt(0)
    buffer_store_dword v252, v253, s[44:47], s100 offen offset:128 sc1
    s_mov_b64 exec, -1
    s_waitcnt lgkmcnt(12)
    v_mfma_f32_16x16x32_bf16 v[0:3], v[64:67], v[228:231], v[0:3]
    ds_read_b64_tr_b16 v[96:97], v200 offset:32768
    ds_read_b64_tr_b16 v[98:99], v200 offset:36864
    v_mfma_f32_16x16x32_bf16 v[0:3], v[68:71], v[232:235], v[0:3]
    ds_read_b64_tr_b16 v[100:101], v200 offset:40960
    ds_read_b64_tr_b16 v[102:103], v200 offset:45056
    s_waitcnt lgkmcnt(12)
    v_mfma_f32_16x16x32_bf16 v[16:19], v[72:75], v[228:231], v[16:19]
    ds_read_b64_tr_b16 v[104:105], v201 offset:32768
    ds_read_b64_tr_b16 v[106:107], v201 offset:36864
    v_mfma_f32_16x16x32_bf16 v[16:19], v[76:79], v[232:235], v[16:19]
    ds_read_b64_tr_b16 v[108:109], v201 offset:40960
    ds_read_b64_tr_b16 v[110:111], v201 offset:45056
    s_waitcnt lgkmcnt(12)
    v_mfma_f32_16x16x32_bf16 v[32:35], v[80:83], v[228:231], v[32:35]
    ds_read_b64_tr_b16 v[112:113], v202 offset:32768
    ds_read_b64_tr_b16 v[114:115], v202 offset:36864
    v_mfma_f32_16x16x32_bf16 v[32:35], v[84:87], v[232:235], v[32:35]
    ds_read_b64_tr_b16 v[116:117], v202 offset:40960
    ds_read_b64_tr_b16 v[118:119], v202 offset:45056
    s_waitcnt lgkmcnt(12)
    v_mfma_f32_16x16x32_bf16 v[48:51], v[88:91], v[228:231], v[48:51]
    ds_read_b64_tr_b16 v[120:121], v203 offset:32768
    ds_read_b64_tr_b16 v[122:123], v203 offset:36864
    v_mfma_f32_16x16x32_bf16 v[48:51], v[92:95], v[232:235], v[48:51]
    ds_read_b64_tr_b16 v[124:125], v203 offset:40960
    ds_read_b64_tr_b16 v[126:127], v203 offset:45056
    s_waitcnt lgkmcnt(12)
    v_mfma_f32_16x16x32_bf16 v[0:3], v[96:99], v[236:239], v[0:3]
    v_mfma_f32_16x16x32_bf16 v[0:3], v[100:103], v[240:243], v[0:3]
    s_waitcnt lgkmcnt(8)
    v_mfma_f32_16x16x32_bf16 v[16:19], v[104:107], v[236:239], v[16:19]
    v_mfma_f32_16x16x32_bf16 v[16:19], v[108:111], v[240:243], v[16:19]
    s_waitcnt lgkmcnt(4)
    v_mfma_f32_16x16x32_bf16 v[32:35], v[112:115], v[236:239], v[32:35]
    v_mfma_f32_16x16x32_bf16 v[32:35], v[116:119], v[240:243], v[32:35]
    s_waitcnt lgkmcnt(0)
    v_mfma_f32_16x16x32_bf16 v[48:51], v[120:123], v[236:239], v[48:51]
    v_mfma_f32_16x16x32_bf16 v[48:51], v[124:127], v[240:243], v[48:51]
    s_load_dword s13, s[8:9], s89 offset:0 glc
    s_load_dword s14, s[8:9], s90 offset:0 glc
    s_load_dword s15, s[8:9], s91 offset:0 glc
    s_mov_b32 s30, 0xffff0000
    s_waitcnt lgkmcnt(0)
    s_mov_b32 s31, 1000000
L_P3W1:
    s_cmp_lg_u32 s13, 0
    s_cbranch_scc1 L_P3G1
    s_load_dword s13, s[8:9], s89 offset:0 glc
    s_load_dword s14, s[8:9], s90 offset:0 glc
    s_load_dword s15, s[8:9], s91 offset:0 glc
    s_sub_u32 s31, s31, 1
    s_waitcnt lgkmcnt(0)
    s_cbranch_scc0 L_P3W1
L_P3G1:
    buffer_load_dwordx4 v[136:139], v206, s[32:35], s36 offen offset:0 sc1
    buffer_load_dwordx4 v[140:143], v206, s[32:35], s36 offen offset:1024 sc1
    s_mov_b32 s31, 1000000
L_P3W2:
    s_cmp_lg_u32 s14, 0
    s_cbranch_scc1 L_P3G2
    s_load_dword s14, s[8:9], s90 offset:0 glc
    s_load_dword s15, s[8:9], s91 offset:0 glc
    s_sub_u32 s31, s31, 1
    s_waitcnt lgkmcnt(0)
    s_cbranch_scc0 L_P3W2
L_P3G2:
    buffer_load_dwordx4 v[144:147], v206, s[32:35], s36 offen offset:2048 sc1
    buffer_load_dwordx4 v[148:151], v206, s[32:35], s36 offen offset:3072 sc1
    s_mov_b32 s31, 1000000
L_P3W3:
    s_cmp_lg_u32 s15, 0
    s_cbranch_scc1 L_P3G3
    s_load_dword s15, s[8:9], s91 offset:0 glc
    s_sub_u32 s31, s31, 1
    s_waitcnt lgkmcnt(0)
    s_cbranch_scc0 L_P3W3
L_P3G3:
    buffer_load_dwordx4 v[152:155], v206, s[32:35], s37 offen offset:0 sc1
    buffer_load_dwordx4 v[156:159], v206, s[32:35], s37 offen offset:1024 sc1
    s_waitcnt vmcnt(5)
    v_lshlrev_b32 v168, 16, v136
    v_and_b32 v169, s30, v136
    v_lshlrev_b32 v170, 16, v137
    v_and_b32 v171, s30, v137
    v_lshlrev_b32 v172, 16, v138
    v_and_b32 v173, s30, v138
    v_lshlrev_b32 v174, 16, v139
    v_and_b32 v175, s30, v139
    v_pk_add_f32 v[0:1], v[0:1], v[168:169]
    v_pk_add_f32 v[2:3], v[2:3], v[170:171]
    v_pk_add_f32 v[16:17], v[16:17], v[172:173]
    v_pk_add_f32 v[18:19], v[18:19], v[174:175]
    s_waitcnt vmcnt(4)
    v_lshlrev_b32 v168, 16, v140
    v_and_b32 v169, s30, v140
    v_lshlrev_b32 v170, 16, v141
    v_and_b32 v171, s30, v141
    v_lshlrev_b32 v172, 16, v142
    v_and_b32 v173, s30, v142
    v_lshlrev_b32 v174, 16, v143
    v_and_b32 v175, s30, v143
    v_pk_add_f32 v[32:33], v[32:33], v[168:169]
    v_pk_add_f32 v[34:35], v[34:35], v[170:171]
    v_pk_add_f32 v[48:49], v[48:49], v[172:173]
    v_pk_add_f32 v[50:51], v[50:51], v[174:175]
    s_waitcnt vmcnt(3)
    v_lshlrev_b32 v168, 16, v144
    v_and_b32 v169, s30, v144
    v_lshlrev_b32 v170, 16, v145
    v_and_b32 v171, s30, v145
    v_lshlrev_b32 v172, 16, v146
    v_and_b32 v173, s30, v146
    v_lshlrev_b32 v174, 16, v147
    v_and_b32 v175, s30, v147
    v_pk_add_f32 v[0:1], v[0:1], v[168:169]
    v_pk_add_f32 v[2:3], v[2:3], v[170:171]
    v_pk_add_f32 v[16:17], v[16:17], v[172:173]
    v_pk_add_f32 v[18:19], v[18:19], v[174:175]
    s_waitcnt vmcnt(2)
    v_lshlrev_b32 v168, 16, v148
    v_and_b32 v169, s30, v148
    v_lshlrev_b32 v170, 16, v149
    v_and_b32 v171, s30, v149
    v_lshlrev_b32 v172, 16, v150
    v_and_b32 v173, s30, v150
    v_lshlrev_b32 v174, 16, v151
    v_and_b32 v175, s30, v151
    v_pk_add_f32 v[32:33], v[32:33], v[168:169]
    v_pk_add_f32 v[34:35], v[34:35], v[170:171]
    v_pk_add_f32 v[48:49], v[48:49], v[172:173]
    v_pk_add_f32 v[50:51], v[50:51], v[174:175]
    s_waitcnt vmcnt(1)
    v_lshlrev_b32 v168, 16, v152
    v_and_b32 v169, s30, v152
    v_lshlrev_b32 v170, 16, v153
    v_and_b32 v171, s30, v153
    v_lshlrev_b32 v172, 16, v154
    v_and_b32 v173, s30, v154
    v_lshlrev_b32 v174, 16, v155
    v_and_b32 v175, s30, v155
    v_pk_add_f32 v[0:1], v[0:1], v[168:169]
    v_pk_add_f32 v[2:3], v[2:3], v[170:171]
    v_pk_add_f32 v[16:17], v[16:17], v[172:173]
    v_pk_add_f32 v[18:19], v[18:19], v[174:175]
    v_cvt_pk_bf16_f32 v0, v0, v1
    v_cvt_pk_bf16_f32 v1, v2, v3
    v_cvt_pk_bf16_f32 v2, v16, v17
    v_cvt_pk_bf16_f32 v3, v18, v19
    s_nop 0
    v_permlane32_swap_b32 v0, v2
    v_permlane32_swap_b32 v1, v3
    s_nop 0
    v_permlane16_swap_b32 v0, v2
    v_permlane16_swap_b32 v1, v3
    buffer_store_dwordx4 v[0:3], v207, s[40:43], 0 offen offset:0 sc1
    s_waitcnt vmcnt(1)
    v_lshlrev_b32 v168, 16, v156
    v_and_b32 v169, s30, v156
    v_lshlrev_b32 v170, 16, v157
    v_and_b32 v171, s30, v157
    v_lshlrev_b32 v172, 16, v158
    v_and_b32 v173, s30, v158
    v_lshlrev_b32 v174, 16, v159
    v_and_b32 v175, s30, v159
    v_pk_add_f32 v[32:33], v[32:33], v[168:169]
    v_pk_add_f32 v[34:35], v[34:35], v[170:171]
    v_pk_add_f32 v[48:49], v[48:49], v[172:173]
    v_pk_add_f32 v[50:51], v[50:51], v[174:175]
    v_cvt_pk_bf16_f32 v32, v32, v33
    v_cvt_pk_bf16_f32 v33, v34, v35
    v_cvt_pk_bf16_f32 v34, v48, v49
    v_cvt_pk_bf16_f32 v35, v50, v51
    s_nop 0
    v_permlane32_swap_b32 v32, v34
    v_permlane32_swap_b32 v33, v35
    s_nop 0
    v_permlane16_swap_b32 v32, v34
    v_permlane16_swap_b32 v33, v35
    buffer_store_dwordx4 v[32:35], v207, s[40:43], 0 offen offset:64 sc1
L_FIN:
L_END:
    s_endpgm
.section .rodata,"a"
.p2align 6
.amdhsa_kernel concat_heads__gqa_block_cached__mha_block_cached__near_ridge_kernel
  .amdhsa_next_free_vgpr 256
  .amdhsa_next_free_sgpr 102
  .amdhsa_accum_offset 256
  .amdhsa_group_segment_fixed_size 0
  .amdhsa_kernarg_size 104
  .amdhsa_user_sgpr_count 2
  .amdhsa_user_sgpr_kernarg_segment_ptr 1
  .amdhsa_system_sgpr_workgroup_id_x 1
.end_amdhsa_kernel
```
